```python
import torch

def _softmax(x, axis=-1):
    return torch.softmax(x, dim=axis)

def _gelu(x):
    return torch.nn.functional.gelu(x, approximate='tanh')

def _silu(x):
    return torch.nn.functional.silu(x)

def _sigmoid(x):
    return torch.sigmoid(x)

def _layernorm(x, axis=-1, eps=1e-05):
    m = x.mean(dim=axis, keepdim=True)
    v = x.var(dim=axis, keepdim=True, unbiased=False)
    return (x - m) / torch.sqrt(v + eps)

def _scatter_add(tgt, idx, src, axis=0):
    return tgt.clone().index_add_(axis, idx, src)

def _segment_sum(src, seg, n):
    out = torch.zeros((n,) + src.shape[1:], dtype=src.dtype)
    return out.index_add_(0, seg, src)

def _pad(x, pw):
    flat = tuple((v for pair in reversed(pw) for v in pair))
    return torch.nn.functional.pad(x, flat)
kernel_name = 'adaLN_cond__sliding_block_cached__swiglu_ffn__decode'

def setup_inputs():

    _w = lambda a: (lambda t: t.to(torch.bfloat16) if t.is_floating_point() else t)(torch.as_tensor(a))

    def _A_setup():
        B, Sq, D = (1, 1, 448)
        Hq, Hkv, Sk, Dh = (16, 8, 16384, 256)
        assert Hq % Hkv == 0, (Hq, Hkv)
        return {'x': _w((lambda *s: torch.randn(*s, dtype=torch.bfloat16) * 0.1)(B, Sq, D)), 'k_cache': _w((lambda *s: torch.randn(*s, dtype=torch.bfloat16) * 0.8)(B, Hkv, Sk, Dh)), 'v_cache': _w((lambda *s: torch.randn(*s, dtype=torch.bfloat16) * 1.6)(B, Hkv, Sk, Dh)), 'wq': _w((lambda *s: torch.randn(*s, dtype=torch.bfloat16) * 0.8)(D, Hq * Dh) * D ** (-0.5)), 'wo': _w((lambda *s: torch.randn(*s, dtype=torch.bfloat16) * 1.6)(Hq * Dh, D) * (Hq * Dh) ** (-0.5))}
    _A_in = _A_setup()

    def _B_setup():
        B, S, D, F = (1, 1, 448, 1792)
        return {'x': _w((lambda *s: torch.randn(*s, dtype=torch.bfloat16) * 0.1)(B, S, D)), 'w_gate': _w((lambda *s: torch.randn(*s, dtype=torch.bfloat16) * 0.2)(D, F)), 'w_up': _w((lambda *s: torch.randn(*s, dtype=torch.bfloat16) * 0.2)(D, F)), 'w_down': _w((lambda *s: torch.randn(*s, dtype=torch.bfloat16) * 0.2)(F, D))}
    _B_in = _B_setup()
    return {'A_x': _A_in['x'], 'A_k_cache': _A_in['k_cache'], 'A_v_cache': _A_in['v_cache'], 'A_wq': _A_in['wq'], 'A_wo': _A_in['wo'], 'B_x': _B_in['x'], 'B_w_gate': _B_in['w_gate'], 'B_w_up': _B_in['w_up'], 'B_w_down': _B_in['w_down'], 'c': _w((lambda *s: torch.randn(*s, dtype=torch.bfloat16) * 0.8)(1, 448) * 8.0), 'w_mod': _w((lambda *s: torch.randn(*s, dtype=torch.bfloat16) * 0.8)(448, 6 * 448) * 448 ** (-0.5) * 8.0)}

def reference(A_x, A_k_cache, A_v_cache, A_wq, A_wo, B_x, B_w_gate, B_w_up, B_w_down, c, w_mod):

    def _A_ref(x, k_cache, v_cache, wq, wo):
        B, Sq, D = x.shape
        Hq, Dh = (16, 256)
        Hkv, Sk = (k_cache.shape[1], k_cache.shape[2])
        W = min(4096, max(256, Sk // 4))
        rep = Hq // Hkv
        q = (lambda x, *d: x.permute(*d))((x @ wq).reshape(B, Sq, Hq, Dh), 0, 2, 1, 3)
        k = (lambda x, n, axis: torch.repeat_interleave(x, n, dim=axis))(k_cache[:, :, Sk - W:, :], rep, axis=1)
        v = (lambda x, n, axis: torch.repeat_interleave(x, n, dim=axis))(v_cache[:, :, Sk - W:, :], rep, axis=1)
        scores = torch.einsum('bhqd,bhkd->bhqk', q, k) * Dh ** (-0.5)
        p = _softmax(scores, axis=-1)
        o = torch.einsum('bhqk,bhkd->bhqd', p, v)
        return (lambda x, *d: x.permute(*d))(o, 0, 2, 1, 3).reshape(B, Sq, Hq * Dh) @ wo

    def _B_ref(x, w_gate, w_up, w_down):
        g = _silu(x @ w_gate)
        u = x @ w_up
        return g * u @ w_down
    x = A_x
    mod = (_silu(c) @ w_mod).reshape(c.shape[0], 6, 1, -1)
    sa, ca, ga, sb, cb, gb = (mod[:, 0].clone(), mod[:, 1].clone(), mod[:, 2].clone(), mod[:, 3].clone(), mod[:, 4].clone(), mod[:, 5].clone())
    h = _layernorm(x, axis=-1) * (1 + ca) + sa
    x = x + ga * _A_ref(h, A_k_cache, A_v_cache, A_wq, A_wo)
    h = _layernorm(x, axis=-1) * (1 + cb) + sb
    x = x + gb * _B_ref(h, B_w_gate, B_w_up, B_w_down)
    return x
```

```asm
; @launch grid=(256,1,1) block=(512,1,1) lds=24576
.amdgcn_target "amdgcn-amd-amdhsa--gfx950"
.text
.globl adaLN_cond__sliding_block_cached__swiglu_ffn__decode_kernel
.p2align 12
.fill 896, 4, 0xbf810000
.p2align 8
.type adaLN_cond__sliding_block_cached__swiglu_ffn__decode_kernel,@function
adaLN_cond__sliding_block_cached__swiglu_ffn__decode_kernel:
    s_cmp_ge_u32 s2, 256
    s_cbranch_scc1 L_exit
    s_load_dwordx4 s[28:31], s[0:1], 96
    s_load_dwordx16 s[4:19], s[0:1], 0
    s_load_dwordx8 s[20:27], s[0:1], 64

    v_lshrrev_b32 v2, 6, v0
    v_and_b32 v1, 63, v0

    s_and_b32 s34, s2, 7

    s_lshr_b32 s35, s2, 3
    v_readfirstlane_b32 s33, v2
    s_cmp_lt_u32 s35, 4
    s_cbranch_scc1 L_F
    s_cmp_lt_u32 s35, 12
    s_cbranch_scc1 L_Q
    s_sub_u32 s46, s35, 12

    s_cmp_eq_u32 s33, 0
    s_cbranch_scc1 L_R
    s_sub_u32 s44, s33, 1
    s_mul_i32 s36, s44, 20
    s_add_u32 s45, s36, s46

    s_sub_u32 s36, s45, 40
    s_lshr_b32 s58, s36, 2
    s_add_u32 s58, s58, 40
    s_and_b32 s36, s36, 3
    s_lshl_b32 s38, s36, 2
    s_lshl_b32 s54, 0x000f000f, s38
    s_lshl_b32 s36, s36, 4
    s_mov_b64 s[56:57], 0xffff
    s_lshl_b64 s[56:57], s[56:57], s36
    s_cmp_lt_u32 s45, 40
    s_cselect_b32 s58, s45, s58
    s_cselect_b32 s54, -1, s54
    s_cselect_b64 s[56:57], -1, s[56:57]
    s_mov_b32 s55, s54
    s_cmp_lt_u32 s45, 56
    s_cselect_b64 s[56:57], s[56:57], 0
    s_lshl_b32 s37, s34, 23
    s_mul_i32 s38, s46, 7
    s_add_u32 s38, s38, s44
    s_sub_u32 s43, s58, s38
    s_add_u32 s43, s43, 980
    s_lshl_b32 s43, s43, 11
    s_lshl_b32 s38, s38, 11
    s_add_u32 s37, s37, s38

    s_add_u32 s37, s37, 6291456
    v_lshrrev_b32 v4, 4, v1
    v_and_b32 v5, 15, v1
    v_lshlrev_b32 v3, 9, v4
    v_lshl_add_u32 v3, v5, 4, v3
    v_and_b32 v6, 3, v1
    v_lshlrev_b32 v6, 4, v6
    v_lshl_add_u32 v6, v4, 6, v6
    v_lshrrev_b32 v5, 2, v5
    v_lshl_add_u32 v2, v5, 9, v6

    s_waitcnt lgkmcnt(0)
    s_add_u32 s6, s6, s37
    s_addc_u32 s7, s7, 0
    s_add_u32 s8, s8, s37
    s_addc_u32 s9, s9, 0
    s_load_dword s32, s[30:31], 0
    s_cmp_ge_u32 s45, 56
    s_cbranch_scc1 skip_1
    v_add_u32 v7, s43, v2
    s_mov_b64 exec, s[54:55]
    global_load_dwordx4 v[64:67], v7, s[6:7] nt
    global_load_dwordx4 v[68:71], v7, s[6:7] offset:256 nt
    s_mov_b64 exec, -1
skip_1:
    global_load_dwordx4 v[8:11], v2, s[6:7] nt
    global_load_dwordx4 v[12:15], v2, s[6:7] offset:256 nt
    v_add_u32 v2, 286720, v2
    s_waitcnt vmcnt(0)
    global_load_dwordx4 v[16:19], v2, s[6:7] nt
    global_load_dwordx4 v[20:23], v2, s[6:7] offset:256 nt
    v_add_u32 v2, 286720, v2
    s_waitcnt vmcnt(0)
    global_load_dwordx4 v[24:27], v2, s[6:7] nt
    global_load_dwordx4 v[28:31], v2, s[6:7] offset:256 nt
    v_add_u32 v2, 286720, v2
    v_and_b32 v168, 1, v1
    v_lshlrev_b32 v168, 4, v168
    v_mov_b32 v169, 0xffff
    v_lshlrev_b32 v171, v168, v169
    v_bfe_u32 v168, v1, 1, 2
    v_cmp_eq_u32 vcc, 1, v168
    v_cmp_eq_u32 s[36:37], 2, v168
    v_cmp_eq_u32 s[38:39], 3, v168
    v_cmp_eq_u32 s[40:41], 0, v168
    v_cndmask_b32 v169, 0, v171, vcc
    v_cndmask_b32 v170, 0, v171, s[36:37]
    v_cndmask_b32 v168, 0, v171, s[40:41]
    v_cndmask_b32 v171, 0, v171, s[38:39]
    s_cmp_lt_u32 s45, 40
    s_cbranch_scc1 z_2
    v_mov_b32 v128, 0
    v_mov_b32 v129, 0
    v_mov_b32 v130, 0
    v_mov_b32 v131, 0
    v_mov_b32 v132, 0
    v_mov_b32 v133, 0
    v_mov_b32 v134, 0
    v_mov_b32 v135, 0
z_2:
    v_bfe_u32 v5, v1, 3, 1
    v_lshl_add_u32 v188, v5, 9, v6
    s_lshl_b32 s36, s44, 2
    v_lshl_add_u32 v189, v5, 5, s36
    v_lshlrev_b32 v190, 5, v5
    s_lshl_b32 s36, s44, 11
    s_add_u32 s36, s36, 2048
    v_lshl_add_u32 v191, v1, 4, s36
    s_mov_b32 s47, 0x3db8aa3b
    v_mov_b32 v198, 0
    s_waitcnt lgkmcnt(0)
    s_add_u32 s32, s32, 0x9e3779b9
    s_add_u32 s14, s30, 1048576
    s_addc_u32 s15, s31, 0
    s_bfe_u32 s50, s32, 0x80008
    s_bfe_u32 s51, s32, 0x80010
    s_lshr_b32 s52, s32, 24
    s_movk_i32 s53, 0xff
    s_and_b32 s48, s32, s53
    v_lshlrev_b32 v192, 4, v1
    s_mul_i32 s36, s34, 40960
    s_lshl_b32 s37, s46, 8
    s_add_u32 s36, s36, s37

    s_add_u32 s36, s36, 419840
    v_bfe_u32 v180, v1, 3, 1
    v_lshlrev_b32 v180, 2, v180
    v_lshrrev_b32 v181, 5, v1
    v_add_u32 v180, v180, v181
    v_mul_u32_u24 v180, 5120, v180
    v_bfe_u32 v181, v1, 4, 1
    v_lshl_add_u32 v180, v181, 7, v180
    v_and_b32 v181, 7, v1
    v_lshl_add_u32 v180, v181, 4, v180
    v_add_u32 v193, s36, v180
    v_mov_b32 v194, s32
    v_mov_b32 v195, s50
    v_mov_b32 v196, s51
    v_mov_b32 v197, s32
    s_mov_b32 s50, 0x07060501
    s_mov_b32 s51, 0x07060502
    s_mov_b32 s52, 0x07060503
    s_waitcnt vmcnt(2)
    global_load_dwordx4 v[32:35], v2, s[6:7] nt
    global_load_dwordx4 v[36:39], v2, s[6:7] offset:256 nt
    v_add_u32 v2, 286720, v2
    s_waitcnt vmcnt(3)
    global_load_dwordx4 v[40:43], v2, s[6:7] nt
    global_load_dwordx4 v[44:47], v2, s[6:7] offset:256 nt
    v_add_u32 v2, 286720, v2
    s_waitcnt vmcnt(3)
    global_load_dwordx4 v[48:51], v2, s[6:7] nt
    global_load_dwordx4 v[52:55], v2, s[6:7] offset:256 nt
    v_add_u32 v2, 286720, v2
    s_waitcnt vmcnt(3)
    global_load_dwordx4 v[56:59], v2, s[6:7] nt
    global_load_dwordx4 v[60:63], v2, s[6:7] offset:256 nt
    s_barrier
    s_cmp_ge_u32 s45, 56
    s_cbranch_scc1 skip_3
    v_add_u32 v7, s43, v3
    s_mov_b64 exec, s[56:57]
    global_load_dwordx4 v[128:131], v7, s[8:9] nt
    global_load_dwordx4 v[132:135], v7, s[8:9] offset:256 nt
    s_mov_b64 exec, -1
skip_3:
    s_waitcnt vmcnt(3)
    global_load_dwordx4 v[72:75], v3, s[8:9] nt
    global_load_dwordx4 v[76:79], v3, s[8:9] offset:256 nt
    v_add_u32 v3, 286720, v3
    s_waitcnt vmcnt(3)
    global_load_dwordx4 v[80:83], v3, s[8:9] nt
    global_load_dwordx4 v[84:87], v3, s[8:9] offset:256 nt
    v_add_u32 v3, 286720, v3
    s_waitcnt vmcnt(3)
    global_load_dwordx4 v[88:91], v3, s[8:9] nt
    global_load_dwordx4 v[92:95], v3, s[8:9] offset:256 nt
    v_add_u32 v3, 286720, v3
    s_mov_b32 s49, 3
    ds_read_b32 v181, v198 offset:1216
    s_waitcnt lgkmcnt(0)
    v_cmp_ne_u32 vcc, 0, v181
    s_cbranch_vccnz L_A_qk
    s_waitcnt vmcnt(3)
    global_load_dwordx4 v[96:99], v3, s[8:9] nt
    global_load_dwordx4 v[100:103], v3, s[8:9] offset:256 nt
    v_add_u32 v3, 286720, v3
    s_mov_b32 s49, 4
    ds_read_b32 v181, v198 offset:1216
    s_waitcnt lgkmcnt(0)
    v_cmp_ne_u32 vcc, 0, v181
    s_cbranch_vccnz L_A_qk
    s_waitcnt vmcnt(3)
    global_load_dwordx4 v[104:107], v3, s[8:9] nt
    global_load_dwordx4 v[108:111], v3, s[8:9] offset:256 nt
    v_add_u32 v3, 286720, v3
    s_mov_b32 s49, 5
    ds_read_b32 v181, v198 offset:1216
    s_waitcnt lgkmcnt(0)
    v_cmp_ne_u32 vcc, 0, v181
    s_cbranch_vccnz L_A_qk
    s_waitcnt vmcnt(3)
    global_load_dwordx4 v[112:115], v3, s[8:9] nt
    global_load_dwordx4 v[116:119], v3, s[8:9] offset:256 nt
    v_add_u32 v3, 286720, v3
    s_mov_b32 s49, 6
    ds_read_b32 v181, v198 offset:1216
    s_waitcnt lgkmcnt(0)
    v_cmp_ne_u32 vcc, 0, v181
    s_cbranch_vccnz L_A_qk
    s_waitcnt vmcnt(3)
    global_load_dwordx4 v[120:123], v3, s[8:9] nt
    global_load_dwordx4 v[124:127], v3, s[8:9] offset:256 nt
    s_mov_b32 s49, 7
    s_mov_b32 s42, 0
L_A_wq:
    ds_read_b32 v181, v198 offset:1216
    s_waitcnt lgkmcnt(0)
    v_cmp_ne_u32 vcc, 0, v181
    s_cbranch_vccnz L_A_qk
    s_sleep 1
    s_add_u32 s42, s42, 1
    s_cmp_lt_u32 s42, 3200000
    s_cbranch_scc1 L_A_wq
L_A_qk:
    ds_read_b128 v[160:163], v188 offset:0
    ds_read_b128 v[164:167], v188 offset:256
    s_cmp_gt_u32 s49, 3
    s_cbranch_scc1 had_4
    s_waitcnt vmcnt(3)
    global_load_dwordx4 v[96:99], v3, s[8:9] nt
    global_load_dwordx4 v[100:103], v3, s[8:9] offset:256 nt
    v_add_u32 v3, 286720, v3
had_4:
    s_waitcnt lgkmcnt(0)
    v_mfma_f32_16x16x32_bf16 v[136:139], v[8:11], v[160:163], 0
    v_mfma_f32_16x16x32_bf16 v[136:139], v[12:15], v[164:167], v[136:139]
    v_mfma_f32_16x16x32_bf16 v[140:143], v[16:19], v[160:163], 0
    v_mfma_f32_16x16x32_bf16 v[140:143], v[20:23], v[164:167], v[140:143]
    v_mfma_f32_16x16x32_bf16 v[144:147], v[24:27], v[160:163], 0
    v_mfma_f32_16x16x32_bf16 v[144:147], v[28:31], v[164:167], v[144:147]
    s_nop 3
    v_mov_b32_dpp v152, v136 quad_perm:[0,0,0,0] row_mask:0xf bank_mask:0xf
    v_add_f32_dpp v152, v137, v152 quad_perm:[1,1,1,1] row_mask:0xf bank_mask:0xf
    v_add_f32_dpp v152, v138, v152 quad_perm:[2,2,2,2] row_mask:0xf bank_mask:0xf
    v_add_f32_dpp v152, v139, v152 quad_perm:[3,3,3,3] row_mask:0xf bank_mask:0xf
    v_mfma_f32_16x16x32_bf16 v[148:151], v[32:35], v[160:163], 0
    v_mfma_f32_16x16x32_bf16 v[148:151], v[36:39], v[164:167], v[148:151]
    v_mov_b32_dpp v153, v140 quad_perm:[0,0,0,0] row_mask:0xf bank_mask:0xf
    v_add_f32_dpp v153, v141, v153 quad_perm:[1,1,1,1] row_mask:0xf bank_mask:0xf
    v_add_f32_dpp v153, v142, v153 quad_perm:[2,2,2,2] row_mask:0xf bank_mask:0xf
    v_add_f32_dpp v153, v143, v153 quad_perm:[3,3,3,3] row_mask:0xf bank_mask:0xf
    v_mfma_f32_16x16x32_bf16 v[136:139], v[40:43], v[160:163], 0
    v_mfma_f32_16x16x32_bf16 v[136:139], v[44:47], v[164:167], v[136:139]
    v_mov_b32_dpp v154, v144 quad_perm:[0,0,0,0] row_mask:0xf bank_mask:0xf
    v_add_f32_dpp v154, v145, v154 quad_perm:[1,1,1,1] row_mask:0xf bank_mask:0xf
    v_add_f32_dpp v154, v146, v154 quad_perm:[2,2,2,2] row_mask:0xf bank_mask:0xf
    v_add_f32_dpp v154, v147, v154 quad_perm:[3,3,3,3] row_mask:0xf bank_mask:0xf
    v_mfma_f32_16x16x32_bf16 v[140:143], v[48:51], v[160:163], 0
    v_mfma_f32_16x16x32_bf16 v[140:143], v[52:55], v[164:167], v[140:143]
    v_mov_b32_dpp v155, v148 quad_perm:[0,0,0,0] row_mask:0xf bank_mask:0xf
    v_add_f32_dpp v155, v149, v155 quad_perm:[1,1,1,1] row_mask:0xf bank_mask:0xf
    v_add_f32_dpp v155, v150, v155 quad_perm:[2,2,2,2] row_mask:0xf bank_mask:0xf
    v_add_f32_dpp v155, v151, v155 quad_perm:[3,3,3,3] row_mask:0xf bank_mask:0xf
    v_mfma_f32_16x16x32_bf16 v[144:147], v[56:59], v[160:163], 0
    v_mfma_f32_16x16x32_bf16 v[144:147], v[60:63], v[164:167], v[144:147]
    v_mov_b32_dpp v156, v136 quad_perm:[0,0,0,0] row_mask:0xf bank_mask:0xf
    v_add_f32_dpp v156, v137, v156 quad_perm:[1,1,1,1] row_mask:0xf bank_mask:0xf
    v_add_f32_dpp v156, v138, v156 quad_perm:[2,2,2,2] row_mask:0xf bank_mask:0xf
    v_add_f32_dpp v156, v139, v156 quad_perm:[3,3,3,3] row_mask:0xf bank_mask:0xf
    v_mfma_f32_16x16x32_bf16 v[148:151], v[64:67], v[160:163], 0
    v_mfma_f32_16x16x32_bf16 v[148:151], v[68:71], v[164:167], v[148:151]
    v_mov_b32_dpp v157, v140 quad_perm:[0,0,0,0] row_mask:0xf bank_mask:0xf
    v_add_f32_dpp v157, v141, v157 quad_perm:[1,1,1,1] row_mask:0xf bank_mask:0xf
    v_add_f32_dpp v157, v142, v157 quad_perm:[2,2,2,2] row_mask:0xf bank_mask:0xf
    v_add_f32_dpp v157, v143, v157 quad_perm:[3,3,3,3] row_mask:0xf bank_mask:0xf
    v_mov_b32_dpp v158, v144 quad_perm:[0,0,0,0] row_mask:0xf bank_mask:0xf
    v_add_f32_dpp v158, v145, v158 quad_perm:[1,1,1,1] row_mask:0xf bank_mask:0xf
    v_add_f32_dpp v158, v146, v158 quad_perm:[2,2,2,2] row_mask:0xf bank_mask:0xf
    v_add_f32_dpp v158, v147, v158 quad_perm:[3,3,3,3] row_mask:0xf bank_mask:0xf
    v_mov_b32_dpp v159, v148 quad_perm:[0,0,0,0] row_mask:0xf bank_mask:0xf
    v_add_f32_dpp v159, v149, v159 quad_perm:[1,1,1,1] row_mask:0xf bank_mask:0xf
    v_add_f32_dpp v159, v150, v159 quad_perm:[2,2,2,2] row_mask:0xf bank_mask:0xf
    v_add_f32_dpp v159, v151, v159 quad_perm:[3,3,3,3] row_mask:0xf bank_mask:0xf
    s_not_b64 exec, s[56:57]
    v_mov_b32 v159, 0xff800000
    s_mov_b64 exec, -1
    v_cvt_pk_bf16_f32 v180, v152, v153
    v_lshlrev_b32 v152, 16, v180
    v_and_b32 v153, 0xffff0000, v180
    v_cvt_pk_bf16_f32 v180, v154, v155
    v_lshlrev_b32 v154, 16, v180
    v_and_b32 v155, 0xffff0000, v180
    v_cvt_pk_bf16_f32 v180, v156, v157
    v_lshlrev_b32 v156, 16, v180
    v_and_b32 v157, 0xffff0000, v180
    v_cvt_pk_bf16_f32 v180, v158, v159
    v_lshlrev_b32 v158, 16, v180
    v_and_b32 v159, 0xffff0000, v180
    v_max3_f32 v180, v152, v153, v154
    v_max3_f32 v181, v155, v156, v157
    v_max3_f32 v180, v180, v158, v159
    v_max_f32 v180, v180, v181
    v_mov_b32 v181, v180
    s_nop 1
    v_permlane16_swap_b32 v181, v180
    v_max_f32 v180, v180, v181
    v_mov_b32 v181, v180
    s_nop 1
    v_permlane32_swap_b32 v181, v180
    v_max_f32 v180, v180, v181
    v_mul_f32 v180, s47, v180
    v_fma_f32 v152, v152, s47, -v180
    v_fma_f32 v153, v153, s47, -v180
    v_fma_f32 v154, v154, s47, -v180
    v_fma_f32 v155, v155, s47, -v180
    v_fma_f32 v156, v156, s47, -v180
    v_fma_f32 v157, v157, s47, -v180
    v_fma_f32 v158, v158, s47, -v180
    v_fma_f32 v159, v159, s47, -v180
    v_exp_f32 v152, v152
    v_exp_f32 v153, v153
    v_exp_f32 v154, v154
    v_exp_f32 v155, v155
    v_exp_f32 v156, v156
    v_exp_f32 v157, v157
    v_exp_f32 v158, v158
    v_exp_f32 v159, v159
    ds_write_b32 v189, v180 offset:1024
    v_add_f32 v182, v152, v153
    v_add_f32 v182, v182, v154
    v_add_f32 v182, v182, v155
    v_add_f32 v182, v182, v156
    v_add_f32 v182, v182, v157
    v_add_f32 v182, v182, v158
    v_add_f32 v182, v182, v159
    v_mov_b32 v183, v182
    s_nop 1
    v_permlane16_swap_b32 v183, v182
    v_add_f32 v182, v182, v183
    v_mov_b32 v183, v182
    s_nop 1
    v_permlane32_swap_b32 v183, v182
    v_add_f32 v182, v182, v183
    ds_write_b32 v189, v182 offset:1088
    s_cmp_gt_u32 s49, 4
    s_cbranch_scc1 had_6
    s_waitcnt vmcnt(3)
    global_load_dwordx4 v[104:107], v3, s[8:9] nt
    global_load_dwordx4 v[108:111], v3, s[8:9] offset:256 nt
    v_add_u32 v3, 286720, v3
had_6:
    s_waitcnt lgkmcnt(0)
    s_barrier
    v_cvt_pk_bf16_f32 v181, v159, v159
    v_and_b32 v36, v181, v168
    v_and_b32 v37, v181, v169
    v_and_b32 v38, v181, v170
    v_and_b32 v39, v181, v171
    v_cvt_pk_bf16_f32 v181, v152, v152
    v_and_b32 v8, v181, v168
    v_and_b32 v9, v181, v169
    v_and_b32 v10, v181, v170
    v_and_b32 v11, v181, v171
    v_cvt_pk_bf16_f32 v181, v153, v153
    v_and_b32 v12, v181, v168
    v_and_b32 v13, v181, v169
    v_and_b32 v14, v181, v170
    v_and_b32 v15, v181, v171
    v_cvt_pk_bf16_f32 v181, v154, v154
    v_and_b32 v16, v181, v168
    v_and_b32 v17, v181, v169
    v_and_b32 v18, v181, v170
    v_and_b32 v19, v181, v171
    v_cvt_pk_bf16_f32 v181, v155, v155
    v_and_b32 v20, v181, v168
    v_and_b32 v21, v181, v169
    v_and_b32 v22, v181, v170
    v_and_b32 v23, v181, v171
    v_cvt_pk_bf16_f32 v181, v156, v156
    v_and_b32 v24, v181, v168
    v_and_b32 v25, v181, v169
    v_and_b32 v26, v181, v170
    v_and_b32 v27, v181, v171
    v_cvt_pk_bf16_f32 v181, v157, v157
    v_and_b32 v28, v181, v168
    v_and_b32 v29, v181, v169
    v_and_b32 v30, v181, v170
    v_and_b32 v31, v181, v171
    v_cvt_pk_bf16_f32 v181, v158, v158
    v_and_b32 v32, v181, v168
    v_and_b32 v33, v181, v169
    v_and_b32 v34, v181, v170
    v_and_b32 v35, v181, v171
    s_cmp_gt_u32 s49, 5
    s_cbranch_scc1 had_7
    s_waitcnt vmcnt(3)
    global_load_dwordx4 v[112:115], v3, s[8:9] nt
    global_load_dwordx4 v[116:119], v3, s[8:9] offset:256 nt
    v_add_u32 v3, 286720, v3
had_7:
    v_mfma_f32_16x16x32_bf16 v[172:175], v[128:131], v[36:39], 0
    v_mfma_f32_16x16x32_bf16 v[176:179], v[132:135], v[36:39], 0
    v_mfma_f32_16x16x32_bf16 v[172:175], v[72:75], v[8:11], v[172:175]
    v_mfma_f32_16x16x32_bf16 v[176:179], v[76:79], v[8:11], v[176:179]
    v_mfma_f32_16x16x32_bf16 v[172:175], v[80:83], v[12:15], v[172:175]
    v_mfma_f32_16x16x32_bf16 v[176:179], v[84:87], v[12:15], v[176:179]
    s_waitcnt vmcnt(6)
    v_mfma_f32_16x16x32_bf16 v[172:175], v[88:91], v[16:19], v[172:175]
    v_mfma_f32_16x16x32_bf16 v[176:179], v[92:95], v[16:19], v[176:179]
    s_cmp_gt_u32 s49, 6
    s_cbranch_scc1 had_8
    s_waitcnt vmcnt(3)
    global_load_dwordx4 v[120:123], v3, s[8:9] nt
    global_load_dwordx4 v[124:127], v3, s[8:9] offset:256 nt
had_8:
    s_waitcnt vmcnt(6)
    v_mfma_f32_16x16x32_bf16 v[172:175], v[96:99], v[20:23], v[172:175]
    v_mfma_f32_16x16x32_bf16 v[176:179], v[100:103], v[20:23], v[176:179]
    s_waitcnt vmcnt(4)
    v_mfma_f32_16x16x32_bf16 v[172:175], v[104:107], v[24:27], v[172:175]
    v_mfma_f32_16x16x32_bf16 v[176:179], v[108:111], v[24:27], v[176:179]
    s_waitcnt vmcnt(2)
    v_mfma_f32_16x16x32_bf16 v[172:175], v[112:115], v[28:31], v[172:175]
    v_mfma_f32_16x16x32_bf16 v[176:179], v[116:119], v[28:31], v[176:179]
    s_waitcnt vmcnt(0)
    v_mfma_f32_16x16x32_bf16 v[172:175], v[120:123], v[32:35], v[172:175]
    v_mfma_f32_16x16x32_bf16 v[176:179], v[124:127], v[32:35], v[176:179]
    s_nop 6
    ds_write_b128 v191, v[172:175]
    ds_write_b128 v191, v[176:179] offset:1024
    s_waitcnt lgkmcnt(0)
    s_barrier
    s_cmp_lg_u32 s33, 1
    s_cbranch_scc1 L_A_end
    ds_read_b128 v[44:47], v190 offset:1152
    ds_read_b128 v[48:51], v190 offset:1168
    ds_read_b128 v[8:11], v192 offset:3072
    ds_read_b128 v[12:15], v192 offset:5120
    ds_read_b128 v[16:19], v192 offset:7168
    ds_read_b128 v[20:23], v192 offset:9216
    ds_read_b128 v[24:27], v192 offset:11264
    ds_read_b128 v[28:31], v192 offset:13312
    ds_read_b128 v[32:35], v192 offset:15360
    s_waitcnt lgkmcnt(6)
    v_pk_mul_f32 v[40:41], v[8:9], v[44:45] op_sel:[0,0] op_sel_hi:[1,0]
    v_pk_mul_f32 v[42:43], v[10:11], v[44:45] op_sel:[0,0] op_sel_hi:[1,0]
    s_waitcnt lgkmcnt(5)
    v_pk_fma_f32 v[40:41], v[12:13], v[44:45], v[40:41] op_sel:[0,1,0] op_sel_hi:[1,1,1]
    v_pk_fma_f32 v[42:43], v[14:15], v[44:45], v[42:43] op_sel:[0,1,0] op_sel_hi:[1,1,1]
    s_waitcnt lgkmcnt(4)
    v_pk_fma_f32 v[40:41], v[16:17], v[46:47], v[40:41] op_sel:[0,0,0] op_sel_hi:[1,0,1]
    v_pk_fma_f32 v[42:43], v[18:19], v[46:47], v[42:43] op_sel:[0,0,0] op_sel_hi:[1,0,1]
    s_waitcnt lgkmcnt(3)
    v_pk_fma_f32 v[40:41], v[20:21], v[46:47], v[40:41] op_sel:[0,1,0] op_sel_hi:[1,1,1]
    v_pk_fma_f32 v[42:43], v[22:23], v[46:47], v[42:43] op_sel:[0,1,0] op_sel_hi:[1,1,1]
    s_waitcnt lgkmcnt(2)
    v_pk_fma_f32 v[40:41], v[24:25], v[48:49], v[40:41] op_sel:[0,0,0] op_sel_hi:[1,0,1]
    v_pk_fma_f32 v[42:43], v[26:27], v[48:49], v[42:43] op_sel:[0,0,0] op_sel_hi:[1,0,1]
    s_waitcnt lgkmcnt(1)
    v_pk_fma_f32 v[40:41], v[28:29], v[48:49], v[40:41] op_sel:[0,1,0] op_sel_hi:[1,1,1]
    v_pk_fma_f32 v[42:43], v[30:31], v[48:49], v[42:43] op_sel:[0,1,0] op_sel_hi:[1,1,1]
    s_waitcnt lgkmcnt(0)
    v_pk_fma_f32 v[40:41], v[32:33], v[50:51], v[40:41] op_sel:[0,0,0] op_sel_hi:[1,0,1]
    v_pk_fma_f32 v[42:43], v[34:35], v[50:51], v[42:43] op_sel:[0,0,0] op_sel_hi:[1,0,1]
    v_perm_b32 v194, v40, v43, s50
    v_perm_b32 v195, v41, v43, s51
    v_perm_b32 v196, v42, v43, s52
    global_store_dwordx4 v193, v[194:197], s[30:31]
    s_lshl_b32 s36, s34, 7
    s_add_u32 s36, s36, 1024
    v_lshl_add_u32 v8, v1, 2, s36
    s_mov_b32 s42, 0
    s_mov_b64 exec, 0x7f
ak_9:
    s_sleep 32
    global_load_dword v9, v8, s[30:31] sc1
    s_waitcnt vmcnt(0)
    v_cmp_ne_u32 vcc, s32, v9
    s_cbranch_vccz akd_10
    s_add_u32 s42, s42, 1
    s_cmp_lt_u32 s42, 5
    s_cbranch_scc1 ak_9
    s_mov_b64 exec, -1
    global_store_dwordx4 v193, v[194:197], s[14:15] sc1

akd_10:
    s_mov_b64 exec, -1
L_A_end:
    s_endpgm
L_R:
    s_waitcnt lgkmcnt(0)
    s_load_dword s32, s[30:31], 0
    s_waitcnt lgkmcnt(0)
    s_add_u32 s32, s32, 0x9e3779b9
    s_add_u32 s14, s30, 1048576
    s_addc_u32 s15, s31, 0
    s_bfe_u32 s50, s32, 0x80008
    s_bfe_u32 s51, s32, 0x80010
    s_lshr_b32 s52, s32, 24
    s_movk_i32 s53, 0xff
    s_and_b32 s48, s32, s53
    v_lshlrev_b32 v60, 4, v1
    s_mul_i32 s36, s34, 40960
    s_lshl_b32 s37, s46, 8
    s_add_u32 s36, s36, s37

    s_add_u32 s36, s36, 409600
    v_bfe_u32 v68, v1, 3, 1
    v_lshlrev_b32 v68, 2, v68
    v_lshrrev_b32 v69, 5, v1
    v_add_u32 v68, v68, v69
    v_mul_u32_u24 v68, 5120, v68
    v_bfe_u32 v69, v1, 4, 1
    v_lshl_add_u32 v68, v69, 7, v68
    v_and_b32 v69, 7, v1
    v_lshl_add_u32 v68, v69, 4, v68
    v_add_u32 v61, s36, v68
    v_mov_b32 v62, s32
    v_mov_b32 v63, s50
    v_mov_b32 v64, s51
    v_mov_b32 v65, s32
    s_mov_b32 s50, 0x07060501
    s_mov_b32 s51, 0x07060502
    s_mov_b32 s52, 0x07060503
    s_lshl_b32 s36, s34, 11
    s_add_u32 s36, s36, 4096
    v_lshl_add_u32 v3, v1, 4, s36
    v_lshrrev_b32 v4, 4, v1
    v_lshlrev_b32 v6, 7, v4
    v_bfe_u32 v4, v1, 2, 1
    v_lshl_add_u32 v6, v4, 6, v6
    v_bfe_u32 v4, v1, 3, 1
    v_lshl_add_u32 v6, v4, 4, v6
    v_lshlrev_b32 v7, 5, v4
    v_and_b32 v5, 3, v1
    v_lshl_add_u32 v6, v5, 2, v6
    s_lshl_b32 s36, s34, 10
    s_lshl_b32 s37, s46, 4
    s_add_u32 s36, s36, s37
    s_add_u32 s36, s36, 24576
    v_lshl_add_u32 v5, v4, 9, s36
    v_mov_b32 v21, 0
    ds_write_b32 v21, v21 offset:1216
    v_mov_b32 v22, 1
    v_lshlrev_b32 v6, 3, v1
    s_waitcnt lgkmcnt(0)
    s_barrier
    s_mov_b32 s42, 0
    s_mov_b64 s[58:59], s[30:31]
poll_11:
    global_load_dwordx4 v[8:11], v3, s[58:59] sc1
    global_load_dwordx4 v[12:15], v3, s[58:59] offset:1024 sc1
    s_waitcnt vmcnt(0)
    v_bitop3_b32 v20, v10, v14, s32 bitop3:0x7e
    v_cmp_ne_u32 vcc, 0, v20
    s_cbranch_vccz pdone_12
    s_add_u32 s42, s42, 1
    s_and_b32 s57, s42, 31
    s_cselect_b64 s[58:59], s[30:31], s[14:15]
    s_cmp_lt_u32 s42, 200000
    s_cbranch_scc1 poll_11
pdone_12:
    ds_write_b64 v6, v[8:9] offset:0
    ds_write_b64 v6, v[12:13] offset:512
    ds_write_b32 v21, v22 offset:1216
    s_barrier
    ds_read_b128 v[44:47], v7 offset:1024
    ds_read_b128 v[48:51], v7 offset:1040
    ds_read_b128 v[8:11], v7 offset:1088
    ds_read_b128 v[12:15], v7 offset:1104
    v_mov_b32 v18, s32
    v_mov_b32 v19, s32
    s_waitcnt lgkmcnt(0)
    v_max3_f32 v16, v44, v45, v46
    v_max3_f32 v17, v47, v48, v49
    v_max3_f32 v16, v16, v17, v50
    v_sub_f32 v44, v44, v16
    v_sub_f32 v45, v45, v16
    v_sub_f32 v46, v46, v16
    v_sub_f32 v47, v47, v16
    v_sub_f32 v48, v48, v16
    v_sub_f32 v49, v49, v16
    v_sub_f32 v50, v50, v16
    v_exp_f32 v44, v44
    v_exp_f32 v45, v45
    v_exp_f32 v46, v46
    v_exp_f32 v47, v47
    v_exp_f32 v48, v48
    v_exp_f32 v49, v49
    v_exp_f32 v50, v50
    v_mul_f32 v17, v8, v44
    v_fmac_f32 v17, v9, v45
    v_fmac_f32 v17, v10, v46
    v_fmac_f32 v17, v11, v47
    v_fmac_f32 v17, v12, v48
    v_fmac_f32 v17, v13, v49
    v_fmac_f32 v17, v14, v50
    s_mov_b64 exec, 0x101
    global_store_dwordx4 v5, v[16:19], s[30:31]
    v_mov_b32 v72, v16
    v_mov_b32 v73, v17
    v_mov_b32 v74, v18
    v_mov_b32 v75, v19
    ds_write_b128 v7, v[44:47] offset:1152
    ds_write_b128 v7, v[48:51] offset:1168
    s_mov_b64 exec, -1
    s_waitcnt lgkmcnt(0)
    s_barrier
    ds_read_b128 v[8:11], v60 offset:2048
    ds_read_b128 v[12:15], v60 offset:4096
    ds_read_b128 v[16:19], v60 offset:6144
    ds_read_b128 v[20:23], v60 offset:8192
    ds_read_b128 v[24:27], v60 offset:10240
    ds_read_b128 v[28:31], v60 offset:12288
    ds_read_b128 v[32:35], v60 offset:14336
    s_waitcnt lgkmcnt(6)
    v_pk_mul_f32 v[40:41], v[8:9], v[44:45] op_sel:[0,0] op_sel_hi:[1,0]
    v_pk_mul_f32 v[42:43], v[10:11], v[44:45] op_sel:[0,0] op_sel_hi:[1,0]
    s_waitcnt lgkmcnt(5)
    v_pk_fma_f32 v[40:41], v[12:13], v[44:45], v[40:41] op_sel:[0,1,0] op_sel_hi:[1,1,1]
    v_pk_fma_f32 v[42:43], v[14:15], v[44:45], v[42:43] op_sel:[0,1,0] op_sel_hi:[1,1,1]
    s_waitcnt lgkmcnt(4)
    v_pk_fma_f32 v[40:41], v[16:17], v[46:47], v[40:41] op_sel:[0,0,0] op_sel_hi:[1,0,1]
    v_pk_fma_f32 v[42:43], v[18:19], v[46:47], v[42:43] op_sel:[0,0,0] op_sel_hi:[1,0,1]
    s_waitcnt lgkmcnt(3)
    v_pk_fma_f32 v[40:41], v[20:21], v[46:47], v[40:41] op_sel:[0,1,0] op_sel_hi:[1,1,1]
    v_pk_fma_f32 v[42:43], v[22:23], v[46:47], v[42:43] op_sel:[0,1,0] op_sel_hi:[1,1,1]
    s_waitcnt lgkmcnt(2)
    v_pk_fma_f32 v[40:41], v[24:25], v[48:49], v[40:41] op_sel:[0,0,0] op_sel_hi:[1,0,1]
    v_pk_fma_f32 v[42:43], v[26:27], v[48:49], v[42:43] op_sel:[0,0,0] op_sel_hi:[1,0,1]
    s_waitcnt lgkmcnt(1)
    v_pk_fma_f32 v[40:41], v[28:29], v[48:49], v[40:41] op_sel:[0,1,0] op_sel_hi:[1,1,1]
    v_pk_fma_f32 v[42:43], v[30:31], v[48:49], v[42:43] op_sel:[0,1,0] op_sel_hi:[1,1,1]
    s_waitcnt lgkmcnt(0)
    v_pk_fma_f32 v[40:41], v[32:33], v[50:51], v[40:41] op_sel:[0,0,0] op_sel_hi:[1,0,1]
    v_pk_fma_f32 v[42:43], v[34:35], v[50:51], v[42:43] op_sel:[0,0,0] op_sel_hi:[1,0,1]
    v_perm_b32 v62, v40, v43, s50
    v_perm_b32 v63, v41, v43, s51
    v_perm_b32 v64, v42, v43, s52
    global_store_dwordx4 v61, v[62:65], s[30:31]
    s_lshl_b32 s36, s34, 7
    s_add_u32 s36, s36, 1024
    v_lshl_add_u32 v8, v1, 2, s36
    s_mov_b32 s42, 0
    s_mov_b64 exec, 0x7f
ak_13:
    s_sleep 32
    global_load_dword v9, v8, s[30:31] sc1
    s_waitcnt vmcnt(0)
    v_cmp_ne_u32 vcc, s32, v9
    s_cbranch_vccz akd_14
    s_add_u32 s42, s42, 1
    s_cmp_lt_u32 s42, 5
    s_cbranch_scc1 ak_13
    s_mov_b64 exec, -1
    global_store_dwordx4 v61, v[62:65], s[14:15] sc1
    s_mov_b64 exec, 0x101
    global_store_dwordx4 v5, v[72:75], s[14:15] sc1
akd_14:
    s_mov_b64 exec, -1
    s_endpgm
.fill 41, 4, 0xbf810000
L_Q:
    s_sub_u32 s44, s35, 4
    v_mov_b32 v103, 4096
    v_lshrrev_b32 v2, 3, v1
    v_and_b32 v3, 7, v1
    v_lshlrev_b32 v3, 4, v3
    s_mov_b32 s54, 0x00ff00ff
    s_mov_b32 s55, 0x00ff00ff
    s_waitcnt lgkmcnt(0)
    s_load_dword s32, s[30:31], 0
    s_cmp_eq_u32 s33, 7
    s_cbranch_scc1 L_Q7
    v_lshrrev_b32 v162, 5, v1
    v_bfe_u32 v148, v1, 4, 1
    v_lshl_add_u32 v162, v148, 1, v162
    v_bfe_u32 v148, v1, 3, 1
    v_lshl_add_u32 v162, v148, 2, v162
    v_lshrrev_b32 v148, 1, v3
    v_add_u32 v162, v162, v148
    s_lshl_b32 s46, s33, 7
    v_lshl_add_u32 v148, v162, 1, s46
    global_load_ushort v160, v148, s[4:5]
    v_min_u32 v149, 55, v1
    v_lshlrev_b32 v149, 4, v149
    global_load_dwordx4 v[104:107], v149, s[4:5]
    s_lshl_b32 s36, s33, 19
    s_lshl_b32 s37, s34, 10
    s_add_u32 s36, s36, s37
    s_lshl_b32 s37, s44, 7
    s_add_u32 s36, s36, s37
    v_lshl_add_u32 v167, v2, 16, v3
    v_add_u32 v167, s36, v167
    global_load_dwordx4 v[8:11], v167, s[10:11] nt
    v_add_u32 v167, 8192, v167
    global_load_dwordx4 v[12:15], v167, s[10:11] nt
    v_add_u32 v167, 8192, v167
    global_load_dwordx4 v[16:19], v167, s[10:11] nt
    v_add_u32 v167, 8192, v167
    global_load_dwordx4 v[20:23], v167, s[10:11] nt
    v_add_u32 v167, 8192, v167
    global_load_dwordx4 v[24:27], v167, s[10:11] nt
    v_add_u32 v167, 8192, v167
    global_load_dwordx4 v[28:31], v167, s[10:11] nt
    v_add_u32 v167, 8192, v167
    global_load_dwordx4 v[32:35], v167, s[10:11] nt
    v_add_u32 v167, 8192, v167
    global_load_dwordx4 v[36:39], v167, s[10:11] nt
    s_lshl_b32 s36, s34, 9
    s_lshl_b32 s37, s33, 6
    s_add_u32 s36, s36, s37
    s_mul_i32 s36, s36, 896
    s_lshl_b32 s37, s44, 7
    s_add_u32 s36, s36, s37
    s_add_u32 s36, s36, 2688
    v_mul_u32_u24 v170, 7168, v2
    v_add3_u32 v170, v170, v3, s36
    s_lshl_b32 s36, s34, 10
    s_lshr_b32 s37, s33, 2
    s_lshl_b32 s37, s37, 9
    s_add_u32 s36, s36, s37
    s_add_u32 s36, s36, 24576
    v_lshrrev_b32 v148, 4, v1
    v_lshl_add_u32 v171, v148, 4, s36
    v_and_b32 v148, 15, v1
    v_min_u32 v148, 4, v148
    v_lshl_add_u32 v171, v148, 6, v171
    s_mul_i32 s36, s34, 40960
    s_mul_i32 s37, s33, 5120
    s_add_u32 s36, s36, s37
    s_add_u32 s36, s36, 411648
    v_lshl_add_u32 v172, v1, 4, s36
    s_mul_i32 s36, s34, 1792
    s_lshl_b32 s37, s44, 8
    s_add_u32 s36, s36, s37
    s_and_b32 s37, s33, 3
    s_mul_i32 s37, s37, 16384
    s_add_u32 s36, s36, s37

    s_add_u32 s36, s36, 180224
    v_bfe_u32 v148, v1, 4, 1
    v_lshlrev_b32 v148, 7, v148
    v_lshrrev_b32 v176, 5, v1
    v_lshl_add_u32 v148, v176, 3, v148
    v_add3_u32 v175, v148, v3, s36
    v_and_b32 v178, 0x37, v1
    v_lshlrev_b32 v178, 3, v178
    v_bfe_u32 v148, v1, 3, 1
    v_lshl_add_u32 v178, v148, 11, v178
    s_lshl_b32 s47, s33, 10
    v_bfe_u32 v4, v1, 1, 1
    v_and_b32 v148, 1, v1
    v_lshl_or_b32 v4, v148, 1, v4
    v_mul_u32_u24 v4, 0x5555, v4
    v_mov_b32 v140, 0
    v_mov_b32 v141, 0
    v_mov_b32 v142, 0
    v_mov_b32 v143, 0
    v_mov_b32 v144, 0
    v_mov_b32 v145, 0
    v_mov_b32 v146, 0
    v_mov_b32 v147, 0
    v_lshl_add_u32 v148, v1, 4, s47
    ds_write_b128 v148, v[140:143]
    v_lshrrev_b32 v164, 4, v1
    v_lshl_add_u32 v164, v164, 6, s47
    v_bfe_u32 v148, v1, 2, 1
    v_lshl_add_u32 v164, v148, 5, v164
    v_bfe_u32 v148, v1, 3, 1
    v_lshl_add_u32 v164, v148, 4, v164
    v_bfe_u32 v148, v1, 3, 1
    v_and_b32 v149, 7, v1
    v_lshl_add_u32 v149, v148, 5, v149
    v_lshrrev_b32 v148, 4, v1
    v_lshl_add_u32 v149, v148, 3, v149
    v_and_b32 v173, 7, v149
    v_lshl_add_u32 v173, v173, 7, s47
    v_bfe_u32 v148, v149, 5, 1
    v_lshl_add_u32 v173, v148, 6, v173
    v_bfe_u32 v148, v149, 3, 1
    v_lshl_add_u32 v173, v148, 4, v173
    v_bfe_u32 v148, v149, 4, 1
    v_lshl_add_u32 v173, v148, 3, v173
    v_and_b32 v163, 7, v162
    v_lshl_add_u32 v163, v163, 7, s47
    v_bfe_u32 v148, v162, 5, 1
    v_lshl_add_u32 v163, v148, 6, v163
    v_bfe_u32 v148, v162, 3, 1
    v_lshl_add_u32 v163, v148, 4, v163
    v_bfe_u32 v148, v162, 4, 1
    v_lshl_add_u32 v163, v148, 3, v163
    s_lshl_b32 s36, s33, 9
    v_lshl_add_u32 v165, v1, 3, s36
    s_add_u32 s36, s36, 32768
    v_lshrrev_b32 v148, 5, v1
    v_mul_u32_u24 v148, 7168, v148
    v_and_b32 v149, 31, v1
    v_lshlrev_b32 v149, 4, v149
    v_add3_u32 v168, v148, v149, s36
    s_waitcnt vmcnt(8) lgkmcnt(0)
    s_add_u32 s32, s32, 0x9e3779b9
    s_add_u32 s14, s30, 1048576
    s_addc_u32 s15, s31, 0
    s_bfe_u32 s50, s32, 0x80008
    s_bfe_u32 s51, s32, 0x80010
    s_lshr_b32 s52, s32, 24
    s_movk_i32 s53, 0xff
    s_and_b32 s48, s32, s53
    v_lshlrev_b32 v160, 16, v160
    v_lshlrev_b32 v108, 16, v104
    v_and_b32 v109, 0xffff0000, v104
    v_lshlrev_b32 v110, 16, v105
    v_and_b32 v111, 0xffff0000, v105
    v_lshlrev_b32 v112, 16, v106
    v_and_b32 v113, 0xffff0000, v106
    v_lshlrev_b32 v114, 16, v107
    v_and_b32 v115, 0xffff0000, v107
    v_cmp_gt_u32 s[46:47], 56, v1
    v_add_f32 v148, v108, v109
    v_add_f32 v148, v148, v110
    v_add_f32 v148, v148, v111
    v_add_f32 v148, v148, v112
    v_add_f32 v148, v148, v113
    v_add_f32 v148, v148, v114
    v_add_f32 v148, v148, v115
    v_cndmask_b32 v148, 0, v148, s[46:47]
    s_nop 1
    v_add_f32_dpp v148, v148, v148 row_ror:1 row_mask:0xf bank_mask:0xf
    s_nop 1
    v_add_f32_dpp v148, v148, v148 row_ror:2 row_mask:0xf bank_mask:0xf
    s_nop 1
    v_add_f32_dpp v148, v148, v148 row_ror:4 row_mask:0xf bank_mask:0xf
    s_nop 1
    v_add_f32_dpp v148, v148, v148 row_ror:8 row_mask:0xf bank_mask:0xf
    v_mov_b32 v149, v148
    s_nop 1
    v_permlane16_swap_b32 v149, v148
    v_add_f32 v148, v148, v149
    v_mov_b32 v149, v148
    s_nop 1
    v_permlane32_swap_b32 v149, v148
    v_add_f32 v148, v148, v149
    v_mul_f32 v148, 0x3b124925, v148
    v_sub_f32 v108, v108, v148
    v_sub_f32 v109, v109, v148
    v_sub_f32 v110, v110, v148
    v_sub_f32 v111, v111, v148
    v_sub_f32 v112, v112, v148
    v_sub_f32 v113, v113, v148
    v_sub_f32 v114, v114, v148
    v_sub_f32 v115, v115, v148
    v_mul_f32 v150, v108, v108
    v_fmac_f32 v150, v109, v109
    v_fmac_f32 v150, v110, v110
    v_fmac_f32 v150, v111, v111
    v_fmac_f32 v150, v112, v112
    v_fmac_f32 v150, v113, v113
    v_fmac_f32 v150, v114, v114
    v_fmac_f32 v150, v115, v115
    v_cndmask_b32 v150, 0, v150, s[46:47]
    s_nop 1
    v_add_f32_dpp v150, v150, v150 row_ror:1 row_mask:0xf bank_mask:0xf
    s_nop 1
    v_add_f32_dpp v150, v150, v150 row_ror:2 row_mask:0xf bank_mask:0xf
    s_nop 1
    v_add_f32_dpp v150, v150, v150 row_ror:4 row_mask:0xf bank_mask:0xf
    s_nop 1
    v_add_f32_dpp v150, v150, v150 row_ror:8 row_mask:0xf bank_mask:0xf
    v_mov_b32 v149, v150
    s_nop 1
    v_permlane16_swap_b32 v149, v150
    v_add_f32 v150, v150, v149
    v_mov_b32 v149, v150
    s_nop 1
    v_permlane32_swap_b32 v149, v150
    v_add_f32 v150, v150, v149
    v_mul_f32 v150, 0x3b124925, v150
    v_cvt_pk_bf16_f32 v150, 0, v150
    v_cvt_pk_bf16_f32 v148, 0, v148
    v_add_f32 v150, 0x3727c5ac, v150
    v_sub_f32 v148, v160, v148
    v_cvt_pk_bf16_f32 v150, 0, v150
    v_sqrt_f32 v150, v150
    v_cvt_pk_bf16_f32 v148, 0, v148
    v_cvt_pk_bf16_f32 v150, 0, v150
    v_rcp_f32 v151, v150
    s_nop 0
    v_mul_f32 v161, v148, v151
    v_fma_f32 v148, -v161, v150, v148
    v_fma_f32 v161, v148, v151, v161
    v_cvt_pk_bf16_f32 v161, 0, v161
    s_waitcnt vmcnt(0)
    s_mov_b32 s42, 0
poll_15:
    global_load_dwordx4 v[104:107], v168, s[30:31] sc1
    global_load_dwordx4 v[108:111], v168, s[30:31] offset:3584 sc1
    s_waitcnt vmcnt(0)
    v_bitop3_b32 v148, v106, v110, s32 bitop3:0x7e
    v_cmp_ne_u32 vcc, 0, v148
    s_cbranch_vccz pdone_16
    s_sleep 8
    s_add_u32 s42, s42, 1
    s_cmp_lt_u32 s42, 200000
    s_cbranch_scc1 poll_15
pdone_16:
    v_permlane32_swap_b32 v104, v105
    v_permlane32_swap_b32 v108, v109
    v_add_f32 v148, v104, v105
    v_add_f32 v149, v108, v109
    v_cvt_pk_bf16_f32 v149, 0, v149
    v_cvt_pk_bf16_f32 v148, 0, v148
    v_add_f32 v149, 1.0, v149
    v_cvt_pk_bf16_f32 v149, 0, v149
    v_mul_f32 v150, v161, v149
    v_cvt_pk_bf16_f32 v150, 0, v150
    v_add_f32 v150, v150, v148
    v_cvt_pk_bf16_f32 v150, 0, v150
    ds_write2_b32 v163, v150, v150 offset0:0 offset1:9
    ds_read_b128 v[124:127], v164 offset:0
    ds_read_b128 v[128:131], v164 offset:256
    ds_read_b128 v[132:135], v164 offset:512
    ds_read_b128 v[136:139], v164 offset:768
    s_waitcnt lgkmcnt(3)
    v_smfmac_f32_16x16x64_bf16 v[140:143], v[124:127], v[8:15], v4
    s_waitcnt lgkmcnt(2)
    v_smfmac_f32_16x16x64_bf16 v[140:143], v[128:131], v[16:23], v4
    s_waitcnt lgkmcnt(1)
    v_smfmac_f32_16x16x64_bf16 v[140:143], v[132:135], v[24:31], v4
    s_waitcnt lgkmcnt(0)
    v_smfmac_f32_16x16x64_bf16 v[140:143], v[136:139], v[32:39], v4
    s_nop 7
    v_permlane32_swap_b32 v140, v141
    v_permlane32_swap_b32 v142, v143
    s_nop 0
    v_add_f32_dpp v140, v141, v140 row_ror:8 row_mask:0xf bank_mask:0xf
    v_add_f32_dpp v141, v143, v142 row_ror:8 row_mask:0xf bank_mask:0xf
    ds_write_b64 v165, v[140:141] offset:8192
    s_waitcnt lgkmcnt(0)
    s_barrier
    s_branch L_W
L_Q7:
    s_lshl_b32 s36, s34, 9
    s_lshl_b32 s37, s33, 6
    s_add_u32 s36, s36, s37
    s_mul_i32 s36, s36, 896
    s_lshl_b32 s37, s44, 7
    s_add_u32 s36, s36, s37
    s_add_u32 s36, s36, 2688
    v_mul_u32_u24 v170, 7168, v2
    v_add3_u32 v170, v170, v3, s36
    s_lshl_b32 s36, s34, 10
    s_lshr_b32 s37, s33, 2
    s_lshl_b32 s37, s37, 9
    s_add_u32 s36, s36, s37
    s_add_u32 s36, s36, 24576
    v_lshrrev_b32 v148, 4, v1
    v_lshl_add_u32 v171, v148, 4, s36
    v_and_b32 v148, 15, v1
    v_min_u32 v148, 4, v148
    v_lshl_add_u32 v171, v148, 6, v171
    s_mul_i32 s36, s34, 40960
    s_mul_i32 s37, s33, 5120
    s_add_u32 s36, s36, s37
    s_add_u32 s36, s36, 411648
    v_lshl_add_u32 v172, v1, 4, s36
    s_mul_i32 s36, s34, 1792
    s_lshl_b32 s37, s44, 8
    s_add_u32 s36, s36, s37
    s_and_b32 s37, s33, 3
    s_mul_i32 s37, s37, 16384
    s_add_u32 s36, s36, s37

    s_add_u32 s36, s36, 180224
    v_bfe_u32 v148, v1, 4, 1
    v_lshlrev_b32 v148, 7, v148
    v_lshrrev_b32 v176, 5, v1
    v_lshl_add_u32 v148, v176, 3, v148
    v_add3_u32 v175, v148, v3, s36
    v_and_b32 v178, 0x37, v1
    v_lshlrev_b32 v178, 3, v178
    v_bfe_u32 v148, v1, 3, 1
    v_lshl_add_u32 v178, v148, 11, v178
    s_lshl_b32 s47, s33, 10
    v_bfe_u32 v4, v1, 1, 1
    v_and_b32 v148, 1, v1
    v_lshl_or_b32 v4, v148, 1, v4
    v_mul_u32_u24 v4, 0x5555, v4
    v_mov_b32 v140, 0
    v_mov_b32 v141, 0
    v_mov_b32 v142, 0
    v_mov_b32 v143, 0
    v_mov_b32 v144, 0
    v_mov_b32 v145, 0
    v_mov_b32 v146, 0
    v_mov_b32 v147, 0
    v_lshl_add_u32 v148, v1, 4, s47
    ds_write_b128 v148, v[140:143]
    v_lshrrev_b32 v164, 4, v1
    v_lshl_add_u32 v164, v164, 6, s47
    v_bfe_u32 v148, v1, 2, 1
    v_lshl_add_u32 v164, v148, 5, v164
    v_bfe_u32 v148, v1, 3, 1
    v_lshl_add_u32 v164, v148, 4, v164
    v_bfe_u32 v148, v1, 3, 1
    v_and_b32 v149, 7, v1
    v_lshl_add_u32 v149, v148, 5, v149
    v_lshrrev_b32 v148, 4, v1
    v_lshl_add_u32 v149, v148, 3, v149
    v_and_b32 v173, 7, v149
    v_lshl_add_u32 v173, v173, 7, s47
    v_bfe_u32 v148, v149, 5, 1
    v_lshl_add_u32 v173, v148, 6, v173
    v_bfe_u32 v148, v149, 3, 1
    v_lshl_add_u32 v173, v148, 4, v173
    v_bfe_u32 v148, v149, 4, 1
    v_lshl_add_u32 v173, v148, 3, v173
    v_lshlrev_b32 v102, 3, v1
    s_lshl_b32 s36, s34, 11
    s_lshl_b32 s37, s44, 8
    s_add_u32 s36, s36, s37
    s_add_u32 s36, s36, 4096
    v_and_b32 v148, 16, v1
    v_lshl_add_u32 v148, v3, 1, v148
    v_add_u32 v103, s36, v148
    v_add_u32 v165, 3584, v102
    s_waitcnt lgkmcnt(0)
    s_add_u32 s32, s32, 0x9e3779b9
    s_add_u32 s14, s30, 1048576
    s_addc_u32 s15, s31, 0
    s_bfe_u32 s50, s32, 0x80008
    s_bfe_u32 s51, s32, 0x80010
    s_lshr_b32 s52, s32, 24
    s_movk_i32 s53, 0xff
    s_and_b32 s48, s32, s53
    v_mov_b32 v42, s32
    v_mov_b32 v43, s32
    s_barrier
    ds_read_b64 v[104:105], v102 offset:8192
    ds_read_b64 v[106:107], v102 offset:8704
    ds_read_b64 v[108:109], v102 offset:9216
    ds_read_b64 v[110:111], v102 offset:9728
    ds_read_b64 v[112:113], v102 offset:10240
    ds_read_b64 v[114:115], v102 offset:10752
    ds_read_b64 v[116:117], v102 offset:11264
    s_waitcnt lgkmcnt(5)
    v_pk_add_f32 v[104:105], v[104:105], v[106:107]
    s_waitcnt lgkmcnt(3)
    v_pk_add_f32 v[108:109], v[108:109], v[110:111]
    v_pk_add_f32 v[104:105], v[104:105], v[108:109]
    s_waitcnt lgkmcnt(1)
    v_pk_add_f32 v[112:113], v[112:113], v[114:115]
    v_pk_add_f32 v[104:105], v[104:105], v[112:113]
    s_waitcnt lgkmcnt(0)
    v_pk_add_f32 v[104:105], v[104:105], v[116:117]
    v_cvt_pk_bf16_f32 v40, v104, v105
    v_cvt_pk_bf16_f32 v41, v104, v105
    s_nop 1
    v_permlane32_swap_b32 v40, v41
    s_mov_b64 exec, 0x00ff00ff
    global_store_dwordx4 v103, v[40:43], s[30:31]
    v_mov_b32 v96, v40
    v_mov_b32 v97, v41
    v_mov_b32 v98, v42
    v_mov_b32 v99, v43
    s_mov_b64 exec, -1
L_W:
    s_barrier
    s_cmp_eq_u32 s44, 7
    s_cbranch_scc1 L_PT
    s_cmp_eq_u32 s33, 7
    s_cselect_b32 s60, 24, -1
    global_load_dwordx4 v[8:11], v170, s[12:13] offset:-2688 nt
    s_waitcnt vmcnt(0)
    global_load_dwordx4 v[12:15], v170, s[12:13] offset:-1792 nt
    s_waitcnt vmcnt(0)
    global_load_dwordx4 v[16:19], v170, s[12:13] offset:-896 nt
    s_waitcnt vmcnt(1)
    global_load_dwordx4 v[20:23], v170, s[12:13] offset:0 nt
    s_waitcnt vmcnt(1)
    global_load_dwordx4 v[24:27], v170, s[12:13] offset:896 nt
    global_load_dwordx4 v[28:31], v170, s[12:13] offset:1792 nt
    global_load_dwordx4 v[32:35], v170, s[12:13] offset:2688 nt
    global_load_dwordx4 v[36:39], v170, s[12:13] offset:3584 nt
    v_lshlrev_b32 v149, 4, v176
    v_lshrrev_b32 v176, v149, s32
    v_lshrrev_b32 v177, 8, v176
    s_mov_b64 s[16:17], -1
    s_mov_b64 s[18:19], -1
    s_mov_b64 s[20:21], -1
    s_mov_b64 s[22:23], -1
    s_mov_b64 s[24:25], -1
    s_mov_b32 s50, 0x0c04000c
    s_mov_b32 s51, 0x0402010c
    s_mov_b32 s42, 0
    s_mov_b64 s[58:59], s[30:31]
    v_mov_b32 v40, 0xff800000
    v_mov_b32 v41, 0
    s_mov_b32 exec_lo, 0x001f001f
    s_mov_b32 exec_hi, 0x001f001f
w1_17:
    global_load_dwordx4 v[40:43], v171, s[58:59] sc1
    s_waitcnt vmcnt(0)
    v_cmp_ne_u32 vcc, s32, v42
    s_cbranch_vccz w1n_18
    s_sleep 2
    s_cmp_eq_u32 s42, s60
    s_cbranch_scc1 L_W_qs
L_W_qb:
    s_add_u32 s42, s42, 1
    s_and_b32 s57, s42, 31
    s_cselect_b64 s[58:59], s[30:31], s[14:15]
    s_cmp_lt_u32 s42, 200000
    s_cbranch_scc1 w1_17
w1n_18:
    s_mov_b64 exec, -1
    global_load_dwordx4 v[60:63], v172, s[58:59] offset:-2048 sc1
    global_load_dwordx4 v[64:67], v172, s[58:59] offset:-1024 sc1
    global_load_dwordx4 v[68:71], v172, s[58:59] offset:0 sc1
    global_load_dwordx4 v[72:75], v172, s[58:59] offset:1024 sc1
    global_load_dwordx4 v[76:79], v172, s[58:59] offset:2048 sc1
    v_max_f32_dpp v148, v40, v40 quad_perm:[1,0,3,2] row_mask:0xf bank_mask:0xf
    s_nop 1
    v_max_f32_dpp v148, v148, v148 quad_perm:[2,3,0,1] row_mask:0xf bank_mask:0xf
    s_nop 1
    v_max_f32_dpp v148, v148, v148 row_half_mirror row_mask:0xf bank_mask:0xf
    v_mov_b32 v149, v148
    s_nop 1
    v_permlane16_swap_b32 v149, v148
    v_max_f32 v148, v148, v149
    v_mov_b32 v149, v148
    s_nop 1
    v_permlane32_swap_b32 v149, v148
    v_max_f32 v148, v148, v149
    v_sub_f32 v44, v40, v148
    v_exp_f32 v44, v44
    s_nop 0
    v_mul_f32 v45, v41, v44
    s_nop 1
    v_add_f32_dpp v148, v45, v45 quad_perm:[1,0,3,2] row_mask:0xf bank_mask:0xf
    s_nop 1
    v_add_f32_dpp v148, v148, v148 quad_perm:[2,3,0,1] row_mask:0xf bank_mask:0xf
    s_nop 1
    v_add_f32_dpp v148, v148, v148 row_half_mirror row_mask:0xf bank_mask:0xf
    v_mov_b32 v149, v148
    s_nop 1
    v_permlane16_swap_b32 v149, v148
    v_add_f32 v148, v148, v149
    v_mov_b32 v149, v148
    s_nop 1
    v_permlane32_swap_b32 v149, v148
    v_add_f32 v148, v148, v149
    v_rcp_f32 v148, v148
    s_nop 0
    v_mul_f32 v44, v44, v148
    s_nop 1
    v_mov_b32_dpp v80, v44 row_newbcast:0 row_mask:0xf bank_mask:0xf
    v_mov_b32_dpp v81, v44 row_newbcast:1 row_mask:0xf bank_mask:0xf
    v_mov_b32_dpp v82, v44 row_newbcast:2 row_mask:0xf bank_mask:0xf
    v_mov_b32_dpp v83, v44 row_newbcast:3 row_mask:0xf bank_mask:0xf
    v_mov_b32_dpp v84, v44 row_newbcast:4 row_mask:0xf bank_mask:0xf
    s_branch w2c_20
w2_19:
    s_mov_b64 exec, s[16:17]
    s_cbranch_execz hs_22
    global_load_dwordx4 v[60:63], v172, s[58:59] offset:-2048 sc1
hs_22:
    s_mov_b64 exec, s[18:19]
    s_cbranch_execz hs_23
    global_load_dwordx4 v[64:67], v172, s[58:59] offset:-1024 sc1
hs_23:
    s_mov_b64 exec, s[20:21]
    s_cbranch_execz hs_24
    global_load_dwordx4 v[68:71], v172, s[58:59] offset:0 sc1
hs_24:
    s_mov_b64 exec, s[22:23]
    s_cbranch_execz hs_25
    global_load_dwordx4 v[72:75], v172, s[58:59] offset:1024 sc1
hs_25:
    s_mov_b64 exec, s[24:25]
    s_cbranch_execz hs_26
    global_load_dwordx4 v[76:79], v172, s[58:59] offset:2048 sc1
hs_26:
    s_mov_b64 exec, -1
w2c_20:
    s_waitcnt vmcnt(0)
    v_bitop3_b32 v148, v63, v67, s32 bitop3:0x7e
    v_bitop3_b32 v149, v71, v75, s32 bitop3:0x7e
    v_bitop3_b32 v148, v148, v79, s32 bitop3:0xf6
    v_or_b32 v148, v148, v149
    v_cmp_ne_u32 vcc, 0, v148
    s_cbranch_vccz wd_21
    v_cmp_ne_u32 s[16:17], s32, v63
    v_cmp_ne_u32 s[18:19], s32, v67
    v_cmp_ne_u32 s[20:21], s32, v71
    v_cmp_ne_u32 s[22:23], s32, v75
    v_cmp_ne_u32 s[24:25], s32, v79

    s_add_u32 s42, s42, 1
    s_and_b32 s57, s42, 31
    s_cselect_b64 s[58:59], s[30:31], s[14:15]
    s_cmp_lt_u32 s42, 200000
    s_cbranch_scc1 w2_19
wd_21:
    v_perm_b32 v63, v61, v60, s50
    v_perm_b32 v67, v65, v64, s50
    v_perm_b32 v71, v69, v68, s50
    v_perm_b32 v75, v73, v72, s50
    v_perm_b32 v79, v77, v76, s50
    v_perm_b32 v63, v62, v63, s51
    v_perm_b32 v67, v66, v67, s51
    v_perm_b32 v71, v70, v71, s51
    v_perm_b32 v75, v74, v75, s51
    v_perm_b32 v79, v78, v79, s51
    v_pk_mul_f32 v[104:105], v[60:61], v[80:81] op_sel:[0,0] op_sel_hi:[1,0]
    v_pk_mul_f32 v[106:107], v[62:63], v[80:81] op_sel:[0,0] op_sel_hi:[1,0]
    v_pk_fma_f32 v[104:105], v[64:65], v[80:81], v[104:105] op_sel:[0,1,0] op_sel_hi:[1,1,1]
    v_pk_fma_f32 v[106:107], v[66:67], v[80:81], v[106:107] op_sel:[0,1,0] op_sel_hi:[1,1,1]
    v_pk_fma_f32 v[104:105], v[68:69], v[82:83], v[104:105] op_sel:[0,0,0] op_sel_hi:[1,0,1]
    v_pk_fma_f32 v[106:107], v[70:71], v[82:83], v[106:107] op_sel:[0,0,0] op_sel_hi:[1,0,1]
    v_pk_fma_f32 v[104:105], v[72:73], v[82:83], v[104:105] op_sel:[0,1,0] op_sel_hi:[1,1,1]
    v_pk_fma_f32 v[106:107], v[74:75], v[82:83], v[106:107] op_sel:[0,1,0] op_sel_hi:[1,1,1]
    v_pk_fma_f32 v[104:105], v[76:77], v[84:85], v[104:105] op_sel:[0,0,0] op_sel_hi:[1,0,1]
    v_pk_fma_f32 v[106:107], v[78:79], v[84:85], v[106:107] op_sel:[0,0,0] op_sel_hi:[1,0,1]
    s_nop 1
    v_permlane32_swap_b32 v104, v106
    v_permlane32_swap_b32 v105, v107
    v_pk_add_f32 v[104:105], v[104:105], v[106:107]
    s_nop 1
    v_permlane16_swap_b32 v104, v105
    v_add_f32 v104, v104, v105
    v_cvt_pk_bf16_f32 v104, 0, v104
    ds_write2_b32 v173, v104, v104 offset0:0 offset1:9
    ds_read_b128 v[124:127], v164 offset:0
    ds_read_b128 v[128:131], v164 offset:256
    ds_read_b128 v[132:135], v164 offset:512
    ds_read_b128 v[136:139], v164 offset:768
    s_waitcnt lgkmcnt(3)
    v_smfmac_f32_16x16x64_bf16 v[144:147], v[124:127], v[8:15], v4
    s_waitcnt lgkmcnt(2)
    v_smfmac_f32_16x16x64_bf16 v[144:147], v[128:131], v[16:23], v4
    s_waitcnt lgkmcnt(1)
    v_smfmac_f32_16x16x64_bf16 v[144:147], v[132:135], v[24:31], v4
    s_waitcnt lgkmcnt(0)
    v_smfmac_f32_16x16x64_bf16 v[144:147], v[136:139], v[32:39], v4
    s_nop 7
    v_permlane32_swap_b32 v144, v145
    v_permlane32_swap_b32 v146, v147
    s_nop 0
    v_add_f32_dpp v144, v145, v144 row_ror:8 row_mask:0xf bank_mask:0xf
    v_add_f32_dpp v145, v147, v146 row_ror:8 row_mask:0xf bank_mask:0xf
    ds_write_b64 v165, v[144:145] offset:12288
    s_waitcnt lgkmcnt(0)
    s_barrier
    s_cmp_lt_u32 s33, 4
    s_cbranch_scc1 L_Q_ack
    ds_read_b64 v[104:105], v178 offset:12288
    ds_read_b64 v[106:107], v178 offset:12800
    ds_read_b64 v[108:109], v178 offset:13312
    ds_read_b64 v[110:111], v178 offset:13824
    s_waitcnt lgkmcnt(2)
    v_pk_add_f32 v[104:105], v[104:105], v[106:107]
    s_waitcnt lgkmcnt(0)
    v_pk_add_f32 v[108:109], v[108:109], v[110:111]
    v_pk_add_f32 v[104:105], v[104:105], v[108:109]
    s_nop 1
    v_add_f32_dpp v104, v104, v104 row_ror:8 row_mask:0xf bank_mask:0xf
    v_add_f32_dpp v105, v105, v105 row_ror:8 row_mask:0xf bank_mask:0xf
    v_bfi_b32 v104, s53, v176, v104
    v_bfi_b32 v105, s53, v177, v105
    s_mov_b64 exec, s[54:55]
    global_store_dwordx2 v175, v[104:105], s[30:31] sc1
    s_branch L_Q_end
L_Q_ack:
    s_cmp_lg_u32 s33, 0
    s_cbranch_scc1 L_Q_end
    s_lshl_b32 s36, s34, 7
    s_lshl_b32 s37, s44, 2
    s_add_u32 s36, s36, s37
    s_add_u32 s36, s36, 1024
    v_mov_b32 v148, s36
    v_mov_b32 v149, s32
    s_mov_b64 exec, 1
    global_store_dword v148, v149, s[30:31]
    s_branch L_Q_end
L_W_qs:
    s_mov_b64 exec, 0x00ff00ff
    global_store_dwordx4 v103, v[96:99], s[14:15] sc1
    s_mov_b32 exec_lo, 0x001f001f
    s_mov_b32 exec_hi, 0x001f001f
    s_branch L_W_qb
L_PT:
    global_load_dwordx4 v[60:63], v172, s[30:31] offset:-2048 sc1
    global_load_dwordx4 v[64:67], v172, s[30:31] offset:-1024 sc1
    global_load_dwordx4 v[68:71], v172, s[30:31] offset:0 sc1
    global_load_dwordx4 v[72:75], v172, s[30:31] offset:1024 sc1
    global_load_dwordx4 v[76:79], v172, s[30:31] offset:2048 sc1
    s_waitcnt vmcnt(0)
    s_cmp_lg_u32 s33, 7
    s_cbranch_scc1 L_Q_end
    s_mov_b32 s42, 0
    s_mov_b32 exec_lo, 0x001f001f
    s_mov_b32 exec_hi, 0x001f001f
L_PT_w:
    s_sleep 16
    global_load_dwordx4 v[40:43], v171, s[30:31] sc1
    s_waitcnt vmcnt(0)
    v_cmp_ne_u32 vcc, s32, v42
    s_cbranch_vccz L_Q_end
    s_add_u32 s42, s42, 1
    s_cmp_lt_u32 s42, 12
    s_cbranch_scc1 L_PT_w
    s_mov_b64 exec, 0x00ff00ff
    global_store_dwordx4 v103, v[96:99], s[14:15] sc1
L_Q_end:
    s_endpgm
.fill 95, 4, 0xbf810000
L_F:
    s_lshl_b32 s45, s35, 3
    s_add_u32 s45, s45, s34
    s_cmp_ge_u32 s45, 28
    s_cbranch_scc1 L_M
    s_and_b32 s46, s45, 1
    s_lshr_b32 s47, s45, 1
    v_lshrrev_b32 v2, 3, v1
    v_and_b32 v3, 7, v1
    v_lshlrev_b32 v3, 4, v3
    s_mov_b32 s54, 0x00ff00ff
    s_mov_b32 s55, 0x00ff00ff
    s_mul_i32 s36, s46, 224
    s_lshl_b32 s37, s33, 5
    s_add_u32 s36, s36, s37
    v_and_b32 v150, 31, v1
    v_add_u32 v148, s36, v150
    v_lshlrev_b32 v148, 1, v148
    s_mul_i32 s36, s36, 5376
    s_lshl_b32 s37, s47, 7
    s_add_u32 s36, s36, s37
    v_mul_u32_u24 v167, 21504, v2
    v_add3_u32 v167, v167, v3, s36
    s_waitcnt lgkmcnt(0)
    s_load_dword s32, s[30:31], 0
    s_cmp_eq_u32 s33, 7
    s_cbranch_scc1 L_F7
    global_load_ushort v166, v148, s[22:23]
    global_load_dwordx4 v[104:107], v167, s[24:25] nt
    v_add_u32 v167, 5376, v167
    global_load_dwordx4 v[108:111], v167, s[24:25] nt
    v_add_u32 v167, 5376, v167
    global_load_dwordx4 v[112:115], v167, s[24:25] nt
    v_add_u32 v167, 5376, v167
    global_load_dwordx4 v[116:119], v167, s[24:25] nt
    v_lshrrev_b32 v162, 5, v1
    v_bfe_u32 v148, v1, 4, 1
    v_lshl_add_u32 v162, v148, 1, v162
    v_bfe_u32 v148, v1, 3, 1
    v_lshl_add_u32 v162, v148, 2, v162
    v_lshrrev_b32 v148, 1, v3
    v_add_u32 v162, v162, v148
    s_lshl_b32 s36, s33, 7
    v_lshl_add_u32 v148, v162, 1, s36
    global_load_ushort v160, v148, s[4:5]
    s_lshl_b32 s47, s33, 10
    v_lshl_add_u32 v148, v1, 1, s36
    global_load_ushort v176, v148, s[22:23]
    s_mul_i32 s36, s33, 344064
    s_lshl_b32 s37, s45, 7
    s_add_u32 s36, s36, s37
    s_add_u32 s36, s36, 1792
    v_mul_u32_u24 v177, 43008, v2
    v_add3_u32 v177, v177, v3, s36
    v_bfe_u32 v4, v1, 1, 1
    v_and_b32 v148, 1, v1
    v_lshl_or_b32 v4, v148, 1, v4
    v_mul_u32_u24 v4, 0x5555, v4
    v_mov_b32 v216, 0
    v_mov_b32 v217, 0
    v_mov_b32 v218, 0
    v_mov_b32 v219, 0
    v_mov_b32 v220, 0
    v_mov_b32 v221, 0
    v_mov_b32 v222, 0
    v_mov_b32 v223, 0
    v_mov_b32 v140, 0
    v_mov_b32 v141, 0
    v_mov_b32 v142, 0
    v_mov_b32 v143, 0
    v_mov_b32 v144, 0
    v_mov_b32 v145, 0
    v_mov_b32 v146, 0
    v_mov_b32 v147, 0
    v_mov_b32 v224, 0
    v_mov_b32 v225, 0
    v_mov_b32 v226, 0
    v_mov_b32 v227, 0
    v_mov_b32 v228, 0
    v_mov_b32 v229, 0
    v_mov_b32 v230, 0
    v_mov_b32 v231, 0
    v_mov_b32 v232, 0
    v_mov_b32 v233, 0
    v_mov_b32 v234, 0
    v_mov_b32 v235, 0
    v_mov_b32 v236, 0
    v_mov_b32 v237, 0
    v_mov_b32 v238, 0
    v_mov_b32 v239, 0
    v_mov_b32 v240, 0
    v_mov_b32 v241, 0
    v_mov_b32 v242, 0
    v_mov_b32 v243, 0
    v_lshl_add_u32 v148, v1, 4, s47
    ds_write_b128 v148, v[216:219]
    v_and_b32 v152, 3, v150
    v_lshl_add_u32 v152, v152, 7, s47
    v_bfe_u32 v148, v150, 4, 1
    v_lshl_add_u32 v152, v148, 6, v152
    v_bfe_u32 v148, v150, 2, 1
    v_lshl_add_u32 v152, v148, 4, v152
    v_bfe_u32 v148, v150, 3, 1
    v_lshl_add_u32 v152, v148, 3, v152
    v_lshrrev_b32 v164, 4, v1
    v_lshl_add_u32 v164, v164, 6, s47
    v_bfe_u32 v148, v1, 2, 1
    v_lshl_add_u32 v164, v148, 5, v164
    v_bfe_u32 v148, v1, 3, 1
    v_lshl_add_u32 v164, v148, 4, v164
    v_and_b32 v182, 7, v1
    v_lshl_add_u32 v182, v182, 7, s47
    v_bfe_u32 v148, v1, 5, 1
    v_lshl_add_u32 v182, v148, 6, v182
    v_bfe_u32 v148, v1, 3, 1
    v_lshl_add_u32 v182, v148, 4, v182
    v_bfe_u32 v148, v1, 4, 1
    v_lshl_add_u32 v182, v148, 3, v182
    v_and_b32 v163, 7, v162
    v_lshl_add_u32 v163, v163, 7, s47
    v_bfe_u32 v148, v162, 5, 1
    v_lshl_add_u32 v163, v148, 6, v163
    v_bfe_u32 v148, v162, 3, 1
    v_lshl_add_u32 v163, v148, 4, v163
    v_bfe_u32 v148, v162, 4, 1
    v_lshl_add_u32 v163, v148, 3, v163
    s_lshl_b32 s36, s33, 8
    v_lshl_add_u32 v181, v162, 2, s36
    s_lshl_b32 s36, s33, 9
    v_lshl_add_u32 v165, v1, 3, s36
    s_waitcnt vmcnt(6)
    v_lshlrev_b32 v166, 16, v166
    v_mul_f32 v148, 0xbfb8aa3b, v166
    v_exp_f32 v148, v148
    s_nop 0
    v_add_f32 v148, 1.0, v148
    v_rcp_f32 v149, v148
    s_nop 0
    v_mul_f32 v150, v166, v149
    v_fma_f32 v148, -v150, v148, v166
    v_fma_f32 v148, v148, v149, v150
    v_cmp_o_f32 vcc, v148, v148
    s_nop 1
    v_cndmask_b32 v148, v150, v148, vcc
    v_cvt_pk_bf16_f32 v166, v148, 0
    ds_write2_b32 v152, v166, v166 offset0:0 offset1:9
    ds_read_b128 v[124:127], v164 offset:0
    ds_read_b128 v[128:131], v164 offset:256
    s_waitcnt vmcnt(2) lgkmcnt(0)
    v_smfmac_f32_16x16x64_bf16 v[216:219], v[124:127], v[104:111], v4
    v_smfmac_f32_16x16x64_bf16 v[216:219], v[128:131], v[112:119], v4
    s_nop 7
    v_permlane32_swap_b32 v216, v217
    v_permlane32_swap_b32 v218, v219
    s_nop 0
    v_add_f32_dpp v216, v217, v216 row_ror:8 row_mask:0xf bank_mask:0xf
    v_add_f32_dpp v217, v219, v218 row_ror:8 row_mask:0xf bank_mask:0xf
    ds_write_b64 v165, v[216:217] offset:8192
    s_waitcnt lgkmcnt(0)
    s_barrier
    s_add_u32 s32, s32, 0x9e3779b9
    s_add_u32 s14, s30, 1048576
    s_addc_u32 s15, s31, 0
    s_bfe_u32 s50, s32, 0x80008
    s_bfe_u32 s51, s32, 0x80010
    s_lshr_b32 s52, s32, 24
    s_movk_i32 s53, 0xff
    s_and_b32 s48, s32, s53
    s_waitcnt vmcnt(0)
    v_lshlrev_b32 v176, 16, v176
    v_mul_f32 v148, 0xbfb8aa3b, v176
    v_exp_f32 v148, v148
    s_nop 0
    v_add_f32 v148, 1.0, v148
    v_rcp_f32 v149, v148
    s_nop 0
    v_mul_f32 v150, v176, v149
    v_fma_f32 v148, -v150, v148, v176
    v_fma_f32 v148, v148, v149, v150
    v_cmp_o_f32 vcc, v148, v148
    s_nop 1
    v_cndmask_b32 v148, v150, v148, vcc
    v_cvt_pk_bf16_f32 v176, v148, 0
    ds_write2_b32 v182, v176, v176 offset0:0 offset1:9
    ds_read_b128 v[124:127], v164 offset:0
    ds_read_b128 v[128:131], v164 offset:256
    ds_read_b128 v[132:135], v164 offset:512
    ds_read_b128 v[136:139], v164 offset:768
    s_barrier
    s_and_b32 s43, s45, 3
    s_cmp_eq_u32 s43, 3
    s_cbranch_scc1 L_F_s1
    global_load_dwordx4 v[184:187], v177, s[24:25] nt
    v_add_u32 v177, 5376, v177
    global_load_dwordx4 v[188:191], v177, s[24:25] nt
    v_add_u32 v177, 5376, v177
    global_load_dwordx4 v[192:195], v177, s[24:25] nt
    v_add_u32 v177, 5376, v177
    global_load_dwordx4 v[196:199], v177, s[24:25] nt
    v_add_u32 v177, 5376, v177
    global_load_dwordx4 v[200:203], v177, s[24:25] nt
    v_add_u32 v177, 5376, v177
    global_load_dwordx4 v[204:207], v177, s[24:25] nt
    v_add_u32 v177, 5376, v177
    global_load_dwordx4 v[208:211], v177, s[24:25] nt
    v_add_u32 v177, 5376, v177
    global_load_dwordx4 v[212:215], v177, s[24:25] nt
L_F_s1:
    s_lshl_b32 s36, s33, 8
    s_add_u32 s36, s36, 49152
    v_lshrrev_b32 v149, 5, v1
    v_mul_u32_u24 v148, 1792, v149
    v_and_b32 v150, 31, v1
    v_lshlrev_b32 v150, 3, v150
    v_add3_u32 v169, v148, v150, s36
    v_lshlrev_b32 v149, 4, v149
    v_sub_u32 v175, 16, v149
    s_mul_i32 s36, s33, 229376
    s_lshl_b32 s37, s45, 7
    s_add_u32 s36, s36, s37
    s_add_u32 s36, s36, 3584
    v_mul_u32_u24 v178, 28672, v2
    v_add3_u32 v178, v178, v3, s36
    v_mov_b32 v179, v178
    s_mul_i32 s36, s45, 57344
    s_lshl_b32 s37, s33, 7
    s_add_u32 s36, s36, s37
    s_add_u32 s36, s36, 2688
    v_mul_u32_u24 v180, 7168, v2
    v_add3_u32 v180, v180, v3, s36
    global_load_dwordx4 v[8:11], v178, s[16:17] offset:-3584 nt
    global_load_dwordx4 v[12:15], v178, s[16:17] offset:0 nt
    global_load_dwordx4 v[16:19], v178, s[16:17] offset:3584 nt
    v_add_u32 v178, 10752, v178
    global_load_dwordx4 v[20:23], v178, s[16:17] offset:-3584 nt
    global_load_dwordx4 v[24:27], v178, s[16:17] offset:0 nt
    global_load_dwordx4 v[28:31], v178, s[16:17] offset:3584 nt
    v_add_u32 v178, 10752, v178
    global_load_dwordx4 v[32:35], v178, s[16:17] offset:-3584 nt
    global_load_dwordx4 v[36:39], v178, s[16:17] offset:0 nt
    s_waitcnt vmcnt(8) lgkmcnt(0)
    s_cmp_eq_u32 s43, 3
    s_cbranch_scc1 L_F_s2
    v_smfmac_f32_16x16x64_bf16 v[220:223], v[124:127], v[184:191], v4
    v_smfmac_f32_16x16x64_bf16 v[220:223], v[128:131], v[192:199], v4
    v_smfmac_f32_16x16x64_bf16 v[220:223], v[132:135], v[200:207], v4
    v_smfmac_f32_16x16x64_bf16 v[220:223], v[136:139], v[208:215], v4
    s_nop 7
    v_permlane32_swap_b32 v220, v221
    v_permlane32_swap_b32 v222, v223
    s_nop 0
    v_add_f32_dpp v220, v221, v220 row_ror:8 row_mask:0xf bank_mask:0xf
    v_add_f32_dpp v221, v223, v222 row_ror:8 row_mask:0xf bank_mask:0xf
    ds_write_b64 v165, v[220:221] offset:8192
    s_waitcnt lgkmcnt(0)
    s_barrier
    s_barrier
L_F_s2:
    s_waitcnt vmcnt(5)
    global_load_dwordx4 v[40:43], v179, s[18:19] offset:-3584 nt
    s_waitcnt vmcnt(5)
    global_load_dwordx4 v[44:47], v179, s[18:19] offset:0 nt
    s_waitcnt vmcnt(5)
    global_load_dwordx4 v[48:51], v179, s[18:19] offset:3584 nt
    v_add_u32 v179, 10752, v179
    s_waitcnt vmcnt(5)
    global_load_dwordx4 v[52:55], v179, s[18:19] offset:-3584 nt
    s_waitcnt vmcnt(5)
    global_load_dwordx4 v[56:59], v179, s[18:19] offset:0 nt
    s_waitcnt vmcnt(5)
    global_load_dwordx4 v[60:63], v179, s[18:19] offset:3584 nt
    v_add_u32 v179, 10752, v179
    s_waitcnt vmcnt(5)
    global_load_dwordx4 v[64:67], v179, s[18:19] offset:-3584 nt
    s_waitcnt vmcnt(5)
    global_load_dwordx4 v[68:71], v179, s[18:19] offset:0 nt
    s_waitcnt vmcnt(5)
    global_load_dwordx4 v[72:75], v180, s[20:21] offset:-2688 nt
    s_waitcnt vmcnt(5)
    global_load_dwordx4 v[76:79], v180, s[20:21] offset:-1792 nt
    s_waitcnt vmcnt(5)
    global_load_dwordx4 v[80:83], v180, s[20:21] offset:-896 nt
    s_waitcnt vmcnt(5)
    global_load_dwordx4 v[84:87], v180, s[20:21] offset:0 nt
    s_lshl_b32 s36, s33, 8
    s_and_b32 s37, s34, 3
    s_mul_i32 s37, s37, 16384
    s_add_u32 s36, s36, s37
    s_add_u32 s36, s36, 183808
    v_lshrrev_b32 v148, 4, v1
    v_mul_u32_u24 v148, 1792, v148
    v_and_b32 v149, 15, v1
    v_lshlrev_b32 v149, 4, v149
    v_add3_u32 v167, v148, v149, s36
    v_lshrrev_b32 v148, 5, v1
    s_lshl_b32 s36, s33, 2
    v_lshl_add_u32 v168, v148, 5, s36

    s_mul_i32 s36, s33, 14336
    s_lshl_b32 s37, s45, 7
    s_add_u32 s36, s36, s37
    s_add_u32 s36, s36, 73728
    v_lshrrev_b32 v148, 4, v1
    v_mul_u32_u24 v148, 3584, v148
    v_add3_u32 v170, v148, v3, s36
    v_and_b32 v171, 0x3ff, v164
    v_mov_b32 v218, s32
    v_mov_b32 v219, s32
    s_mov_b32 s49, 0x07060302
    s_mov_b32 s42, 0
poll_27:
    global_load_dwordx2 v[104:105], v169, s[30:31] sc1
    global_load_dwordx2 v[106:107], v169, s[30:31] offset:3584 sc1
    s_waitcnt vmcnt(0)
    v_bitop3_b32 v148, v105, v107, s32 bitop3:0x7e
    v_cmp_ne_u32 vcc, 0, v148
    s_cbranch_vccz pdone_28
    s_sleep 4
    s_add_u32 s42, s42, 1
    s_cmp_lt_u32 s42, 200000
    s_cbranch_scc1 poll_27
pdone_28:
    s_waitcnt vmcnt(5)
    global_load_dwordx4 v[88:91], v180, s[20:21] offset:896 nt
    s_waitcnt vmcnt(5)
    global_load_dwordx4 v[92:95], v180, s[20:21] offset:1792 nt
    s_waitcnt vmcnt(5)
    global_load_dwordx4 v[96:99], v180, s[20:21] offset:2688 nt
    s_waitcnt vmcnt(5)
    global_load_dwordx4 v[100:103], v180, s[20:21] offset:3584 nt
    v_lshlrev_b32 v160, 16, v160
    v_mov_b32 v105, v104
    v_mov_b32 v107, v106
    s_nop 0
    v_permlane32_swap_b32 v104, v105
    v_permlane32_swap_b32 v106, v107
    v_lshlrev_b32 v172, v175, v104
    v_and_b32 v172, 0xffff0000, v172
    v_lshlrev_b32 v173, v175, v105
    v_and_b32 v173, 0xffff0000, v173
    v_lshlrev_b32 v174, v175, v106
    v_and_b32 v174, 0xffff0000, v174
    v_lshlrev_b32 v154, v175, v107
    v_and_b32 v154, 0xffff0000, v154
    v_add_f32 v174, 1.0, v174
    v_cvt_pk_bf16_f32 v174, 0, v174
    ds_write_b32 v181, v154 offset:13696
    ds_write2_b32 v163, v174, v174 offset0:0 offset1:9
    ds_read_b128 v[124:127], v164 offset:0
    ds_read_b128 v[128:131], v164 offset:256
    ds_read_b128 v[132:135], v164 offset:512
    ds_read_b128 v[136:139], v164 offset:768
    s_waitcnt lgkmcnt(3)
    v_smfmac_f32_16x16x64_bf16 v[228:231], v[124:127], v[8:15], v4
    v_smfmac_f32_16x16x64_bf16 v[232:235], v[124:127], v[40:47], v4
    s_waitcnt lgkmcnt(2)
    v_smfmac_f32_16x16x64_bf16 v[228:231], v[128:131], v[16:23], v4
    v_smfmac_f32_16x16x64_bf16 v[232:235], v[128:131], v[48:55], v4
    s_waitcnt lgkmcnt(1)
    v_smfmac_f32_16x16x64_bf16 v[228:231], v[132:135], v[24:31], v4
    v_smfmac_f32_16x16x64_bf16 v[232:235], v[132:135], v[56:63], v4
    s_waitcnt lgkmcnt(0)
    v_smfmac_f32_16x16x64_bf16 v[228:231], v[136:139], v[32:39], v4
    v_smfmac_f32_16x16x64_bf16 v[232:235], v[136:139], v[64:71], v4
    ds_write2_b32 v163, v173, v173 offset0:0 offset1:9
    ds_read_b128 v[124:127], v164 offset:0
    ds_read_b128 v[128:131], v164 offset:256
    ds_read_b128 v[132:135], v164 offset:512
    ds_read_b128 v[136:139], v164 offset:768
    s_waitcnt lgkmcnt(3)
    v_smfmac_f32_16x16x64_bf16 v[236:239], v[124:127], v[8:15], v4
    v_smfmac_f32_16x16x64_bf16 v[240:243], v[124:127], v[40:47], v4
    s_waitcnt lgkmcnt(2)
    v_smfmac_f32_16x16x64_bf16 v[236:239], v[128:131], v[16:23], v4
    v_smfmac_f32_16x16x64_bf16 v[240:243], v[128:131], v[48:55], v4
    s_waitcnt lgkmcnt(1)
    v_smfmac_f32_16x16x64_bf16 v[236:239], v[132:135], v[24:31], v4
    v_smfmac_f32_16x16x64_bf16 v[240:243], v[132:135], v[56:63], v4
    s_waitcnt lgkmcnt(0)
    v_smfmac_f32_16x16x64_bf16 v[236:239], v[136:139], v[32:39], v4
    v_smfmac_f32_16x16x64_bf16 v[240:243], v[136:139], v[64:71], v4
    v_permlane32_swap_b32 v228, v229
    v_permlane32_swap_b32 v230, v231
    v_permlane32_swap_b32 v232, v233
    v_permlane32_swap_b32 v234, v235
    v_add_f32_dpp v228, v229, v228 row_ror:8 row_mask:0xf bank_mask:0xf
    v_add_f32_dpp v229, v231, v230 row_ror:8 row_mask:0xf bank_mask:0xf
    v_add_f32_dpp v228, v232, v233 row_ror:8 row_mask:0xf bank_mask:0xc
    v_add_f32_dpp v229, v234, v235 row_ror:8 row_mask:0xf bank_mask:0xc
    ds_write_b64 v165, v[228:229] offset:16384
    v_permlane32_swap_b32 v236, v237
    v_permlane32_swap_b32 v238, v239
    v_permlane32_swap_b32 v240, v241
    v_permlane32_swap_b32 v242, v243
    v_add_f32_dpp v236, v237, v236 row_ror:8 row_mask:0xf bank_mask:0xf
    v_add_f32_dpp v237, v239, v238 row_ror:8 row_mask:0xf bank_mask:0xf
    v_add_f32_dpp v236, v240, v241 row_ror:8 row_mask:0xf bank_mask:0xc
    v_add_f32_dpp v237, v242, v243 row_ror:8 row_mask:0xf bank_mask:0xc
    ds_write_b64 v165, v[236:237] offset:19968
    s_waitcnt lgkmcnt(0)
    s_barrier
    v_mul_f32 v173, v172, v174
    v_mul_f32 v174, v160, v174
    s_mov_b32 s42, 0
poll_29:
    global_load_dwordx4 v[104:107], v167, s[30:31] offset:-3584 sc1
    global_load_dwordx4 v[108:111], v167, s[30:31] offset:3584 sc1
    s_waitcnt vmcnt(0)
    v_xor_b32 v104, s48, v104
    v_xor_b32 v105, s50, v105
    v_xor_b32 v106, s51, v106
    v_xor_b32 v107, s52, v107
    v_xor_b32 v108, s48, v108
    v_xor_b32 v109, s50, v109
    v_xor_b32 v110, s51, v110
    v_xor_b32 v111, s52, v111
    v_or3_b32 v148, v104, v105, v106
    v_or3_b32 v149, v107, v108, v109
    v_or3_b32 v148, v148, v110, v111
    v_bitop3_b32 v148, v148, v149, s53 bitop3:0xa8
    v_cmp_ne_u32 vcc, 0, v148
    s_cbranch_vccz pdone_30
    s_add_u32 s42, s42, 1
    s_cmp_lt_u32 s42, 200000
    s_cbranch_scc1 poll_29
pdone_30:
    v_pk_add_f32 v[104:105], v[104:105], v[108:109]
    v_pk_add_f32 v[106:107], v[106:107], v[110:111]
    s_nop 0
    v_permlane32_swap_b32 v104, v105
    v_permlane32_swap_b32 v106, v107
    v_add_f32 v104, v104, v105
    v_add_f32 v106, v106, v107
    s_nop 1
    v_permlane16_swap_b32 v104, v106
    v_add_f32 v104, v104, v106
    v_fma_f32 v150, v104, v173, v174
    v_and_b32 v151, 0xffff0000, v150
    v_sub_f32 v151, v150, v151
    v_perm_b32 v150, v150, v151, s49
    ds_write2_b32 v163, v150, v150 offset0:0 offset1:9
    ds_read_b128 v[124:127], v164 offset:0
    ds_read_b128 v[128:131], v164 offset:256
    ds_read_b128 v[132:135], v164 offset:512
    ds_read_b128 v[136:139], v164 offset:768
    v_fmac_f32 v160, v104, v172
    v_mul_f32 v149, v160, v160
    s_nop 0
    v_add_f32_dpp v148, v160, v160 row_ror:1 row_mask:0xf bank_mask:0xf
    v_add_f32_dpp v149, v149, v149 row_ror:1 row_mask:0xf bank_mask:0xf
    ds_write_b32 v181, v160 offset:11904
    v_add_f32_dpp v148, v148, v148 row_ror:2 row_mask:0xf bank_mask:0xf
    v_add_f32_dpp v149, v149, v149 row_ror:2 row_mask:0xf bank_mask:0xf
    s_nop 0
    v_add_f32_dpp v148, v148, v148 row_ror:4 row_mask:0xf bank_mask:0xf
    v_add_f32_dpp v149, v149, v149 row_ror:4 row_mask:0xf bank_mask:0xf
    s_nop 0
    v_add_f32_dpp v148, v148, v148 row_ror:8 row_mask:0xf bank_mask:0xf
    v_add_f32_dpp v149, v149, v149 row_ror:8 row_mask:0xf bank_mask:0xf
    s_nop 1
    v_permlane32_swap_b32 v148, v149
    v_add_f32 v148, v148, v149
    v_mov_b32 v149, v148
    s_nop 1
    v_permlane16_swap_b32 v149, v148
    v_add_f32 v148, v148, v149
    ds_write_b32 v168, v148 offset:11776
    s_waitcnt lgkmcnt(5)
    v_smfmac_f32_16x16x64_bf16 v[140:143], v[124:127], v[8:15], v4
    v_smfmac_f32_16x16x64_bf16 v[144:147], v[124:127], v[40:47], v4
    s_waitcnt lgkmcnt(4)
    v_smfmac_f32_16x16x64_bf16 v[140:143], v[128:131], v[16:23], v4
    v_smfmac_f32_16x16x64_bf16 v[144:147], v[128:131], v[48:55], v4
    s_waitcnt lgkmcnt(3)
    v_smfmac_f32_16x16x64_bf16 v[140:143], v[132:135], v[24:31], v4
    v_smfmac_f32_16x16x64_bf16 v[144:147], v[132:135], v[56:63], v4
    s_waitcnt lgkmcnt(2)
    v_smfmac_f32_16x16x64_bf16 v[140:143], v[136:139], v[32:39], v4
    v_smfmac_f32_16x16x64_bf16 v[144:147], v[136:139], v[64:71], v4
    s_nop 6
    v_permlane32_swap_b32 v140, v141
    v_permlane32_swap_b32 v142, v143
    v_permlane32_swap_b32 v144, v145
    v_permlane32_swap_b32 v146, v147
    v_add_f32_dpp v140, v141, v140 row_ror:8 row_mask:0xf bank_mask:0xf
    v_add_f32_dpp v141, v143, v142 row_ror:8 row_mask:0xf bank_mask:0xf
    v_add_f32_dpp v140, v144, v145 row_ror:8 row_mask:0xf bank_mask:0xc
    v_add_f32_dpp v141, v146, v147 row_ror:8 row_mask:0xf bank_mask:0xc
    ds_write_b64 v165, v[140:141] offset:8192
    s_waitcnt lgkmcnt(0)
    s_barrier
    s_barrier
    ds_read_b128 v[124:127], v171 offset:7168
    ds_read_b128 v[128:131], v171 offset:7424
    ds_read_b128 v[132:135], v171 offset:7680
    ds_read_b128 v[136:139], v171 offset:7936
    s_waitcnt lgkmcnt(3)
    v_smfmac_f32_16x16x64_bf16 v[224:227], v[124:127], v[72:79], v4
    s_waitcnt lgkmcnt(2)
    v_smfmac_f32_16x16x64_bf16 v[224:227], v[128:131], v[80:87], v4
    s_waitcnt lgkmcnt(1)
    v_smfmac_f32_16x16x64_bf16 v[224:227], v[132:135], v[88:95], v4
    s_waitcnt lgkmcnt(0)
    v_smfmac_f32_16x16x64_bf16 v[224:227], v[136:139], v[96:103], v4
    s_nop 7
    v_permlane32_swap_b32 v224, v225
    v_permlane32_swap_b32 v226, v227
    s_nop 0
    v_add_f32_dpp v216, v225, v224 row_ror:8 row_mask:0xf bank_mask:0xf
    v_add_f32_dpp v217, v227, v226 row_ror:8 row_mask:0xf bank_mask:0xf
    s_mov_b64 exec, s[54:55]
    global_store_dwordx4 v170, v[216:219], s[30:31] sc1
    s_waitcnt vmcnt(0)
    s_barrier
    s_branch L_F_end
.fill 263, 4, 0xbf810000
L_F7:
    v_lshrrev_b32 v149, 4, v1
    v_and_b32 v148, 7, v1
    v_lshl_add_u32 v148, v149, 3, v148
    v_lshlrev_b32 v102, 3, v1
    s_mul_i32 s36, s46, 7168
    s_lshl_b32 s37, s47, 9
    s_add_u32 s36, s36, s37
    s_add_u32 s36, s36, 32768
    v_lshl_add_u32 v103, v148, 4, s36
    s_lshl_b32 s36, s45, 8
    s_add_u32 s36, s36, 49152
    v_lshl_add_u32 v101, v148, 3, s36
    v_mov_b32 v36, 0
    v_mov_b32 v37, 0
    v_mov_b32 v38, 0
    v_mov_b32 v39, 0
    v_lshlrev_b32 v148, 4, v1
    ds_write_b128 v148, v[36:39] offset:7168
    s_waitcnt lgkmcnt(0)
    s_add_u32 s32, s32, 0x9e3779b9
    s_add_u32 s14, s30, 1048576
    s_addc_u32 s15, s31, 0
    s_barrier
    ds_read_b64 v[8:9], v102 offset:8192
    ds_read_b64 v[10:11], v102 offset:8704
    ds_read_b64 v[12:13], v102 offset:9216
    ds_read_b64 v[14:15], v102 offset:9728
    ds_read_b64 v[16:17], v102 offset:10240
    ds_read_b64 v[18:19], v102 offset:10752
    ds_read_b64 v[20:21], v102 offset:11264
    s_waitcnt lgkmcnt(5)
    v_pk_add_f32 v[8:9], v[8:9], v[10:11]
    s_waitcnt lgkmcnt(3)
    v_pk_add_f32 v[12:13], v[12:13], v[14:15]
    v_pk_add_f32 v[8:9], v[8:9], v[12:13]
    s_waitcnt lgkmcnt(1)
    v_pk_add_f32 v[16:17], v[16:17], v[18:19]
    v_pk_add_f32 v[8:9], v[8:9], v[16:17]
    s_waitcnt lgkmcnt(0)
    v_pk_add_f32 v[8:9], v[8:9], v[20:21]
    v_mov_b32 v10, s32
    v_mov_b32 v11, s32
    s_mov_b64 exec, s[54:55]
    global_store_dwordx4 v103, v[8:11], s[30:31] sc1
    s_mov_b64 exec, -1
    s_barrier
    v_bfe_u32 v149, v1, 3, 1
    v_lshrrev_b32 v148, 5, v1
    v_lshl_add_u32 v149, v148, 1, v149
    v_bfe_u32 v148, v1, 4, 1
    v_lshl_add_u32 v149, v148, 2, v149
    v_lshrrev_b32 v148, 1, v3
    v_add_u32 v149, v149, v148
    s_movk_i32 s36, 7168
    v_and_b32 v104, 7, v149
    v_lshl_add_u32 v104, v104, 7, s36
    v_bfe_u32 v148, v149, 5, 1
    v_lshl_add_u32 v104, v148, 6, v104
    v_bfe_u32 v148, v149, 3, 1
    v_lshl_add_u32 v104, v148, 4, v104
    v_bfe_u32 v148, v149, 4, 1
    v_lshl_add_u32 v104, v148, 3, v104
    s_lshr_b32 s36, s45, 2
    s_lshl_b32 s36, s36, 6
    s_and_b32 s37, s45, 1
    s_lshl_b32 s37, s37, 2
    s_add_u32 s36, s36, s37
    s_and_b32 s37, s45, 2
    s_add_u32 s36, s36, s37
    v_lshrrev_b32 v148, 5, v1
    v_add_lshl_u32 v107, s36, v148, 1
    v_add_u32 v107, v107, v3
    v_lshlrev_b32 v106, 1, v107
    s_movk_i32 s56, 0xff
    s_movk_i32 s57, 0xff
    s_mul_i32 s36, s45, 3584
    s_add_u32 s36, s36, 73728
    v_lshl_add_u32 v108, v1, 4, s36
    v_mov_b32 v38, s32
    v_mov_b32 v110, 0
    v_mov_b32 v111, s32
    v_and_b32 v112, 15, v1
    v_lshlrev_b32 v112, 2, v112
    v_and_b32 v148, 7, v1
    v_cmp_eq_u32 vcc, 7, v148
    s_nop 1
    v_cndmask_b32 v148, -1, 0, vcc
    ds_write_b32 v112, v148 offset:11776
    s_and_b32 s43, s45, 3
    s_cmp_eq_u32 s43, 3
    s_cbranch_scc1 L_G_s1
    s_barrier
    ds_read_b64 v[8:9], v102 offset:8192
    ds_read_b64 v[10:11], v102 offset:8704
    ds_read_b64 v[12:13], v102 offset:9216
    ds_read_b64 v[14:15], v102 offset:9728
    ds_read_b64 v[16:17], v102 offset:10240
    ds_read_b64 v[18:19], v102 offset:10752
    ds_read_b64 v[20:21], v102 offset:11264
    s_waitcnt lgkmcnt(5)
    v_pk_add_f32 v[8:9], v[8:9], v[10:11]
    s_waitcnt lgkmcnt(3)
    v_pk_add_f32 v[12:13], v[12:13], v[14:15]
    v_pk_add_f32 v[8:9], v[8:9], v[12:13]
    s_waitcnt lgkmcnt(1)
    v_pk_add_f32 v[16:17], v[16:17], v[18:19]
    v_pk_add_f32 v[8:9], v[8:9], v[16:17]
    s_waitcnt lgkmcnt(0)
    v_pk_add_f32 v[8:9], v[8:9], v[20:21]
    v_cvt_pk_bf16_f32 v8, v8, v9
    v_mov_b32 v9, s32
    s_mov_b64 exec, s[54:55]
    global_store_dwordx2 v101, v[8:9], s[30:31] sc1
    s_mov_b64 exec, -1
    s_barrier
L_G_s1:
    s_waitcnt lgkmcnt(0)
    s_barrier
    ds_read_b64 v[44:45], v102 offset:16384
    ds_read_b64 v[46:47], v102 offset:16896
    ds_read_b64 v[48:49], v102 offset:17408
    ds_read_b64 v[50:51], v102 offset:17920
    ds_read_b64 v[52:53], v102 offset:18432
    ds_read_b64 v[54:55], v102 offset:18944
    ds_read_b64 v[56:57], v102 offset:19456
    s_waitcnt lgkmcnt(5)
    v_pk_add_f32 v[44:45], v[44:45], v[46:47]
    s_waitcnt lgkmcnt(3)
    v_pk_add_f32 v[48:49], v[48:49], v[50:51]
    v_pk_add_f32 v[44:45], v[44:45], v[48:49]
    s_waitcnt lgkmcnt(1)
    v_pk_add_f32 v[52:53], v[52:53], v[54:55]
    v_pk_add_f32 v[44:45], v[44:45], v[52:53]
    s_waitcnt lgkmcnt(0)
    v_pk_add_f32 v[44:45], v[44:45], v[56:57]
    ds_read_b64 v[60:61], v102 offset:19968
    ds_read_b64 v[62:63], v102 offset:20480
    ds_read_b64 v[64:65], v102 offset:20992
    ds_read_b64 v[66:67], v102 offset:21504
    ds_read_b64 v[68:69], v102 offset:22016
    ds_read_b64 v[70:71], v102 offset:22528
    ds_read_b64 v[72:73], v102 offset:23040
    s_waitcnt lgkmcnt(5)
    v_pk_add_f32 v[60:61], v[60:61], v[62:63]
    s_waitcnt lgkmcnt(3)
    v_pk_add_f32 v[64:65], v[64:65], v[66:67]
    v_pk_add_f32 v[60:61], v[60:61], v[64:65]
    s_waitcnt lgkmcnt(1)
    v_pk_add_f32 v[68:69], v[68:69], v[70:71]
    v_pk_add_f32 v[60:61], v[60:61], v[68:69]
    s_waitcnt lgkmcnt(0)
    v_pk_add_f32 v[60:61], v[60:61], v[72:73]
    s_mov_b32 s42, 0
st_31:
    ds_read_b32 v148, v112 offset:11776
    s_waitcnt lgkmcnt(0)
    v_cmp_eq_u32 vcc, -1, v148
    s_cbranch_vccz std_32
    s_sleep 1
    s_add_u32 s42, s42, 1
    s_cmp_lt_u32 s42, 3200000
    s_cbranch_scc1 st_31
std_32:
    v_add_f32_dpp v148, v148, v148 quad_perm:[1,0,3,2] row_mask:0xf bank_mask:0xf
    s_nop 1
    v_add_f32_dpp v148, v148, v148 quad_perm:[2,3,0,1] row_mask:0xf bank_mask:0xf
    s_nop 1
    v_add_f32_dpp v148, v148, v148 row_half_mirror row_mask:0xf bank_mask:0xf
    v_mul_f32 v148, 0x3b124925, v148
    v_mov_b32 v150, v148
    s_nop 1
    v_mov_b32_dpp v148, v150 row_ror:8 row_mask:0xf bank_mask:0xc
    v_mov_b32_dpp v150, v150 row_ror:8 row_mask:0xf bank_mask:0x3
    v_fma_f32 v150, -v148, v148, v150
    v_max_f32 v150, 0, v150
    s_mov_b64 vcc, s[54:55]
    s_barrier
    ds_read_b64 v[8:9], v102 offset:8192
    ds_read_b64 v[10:11], v102 offset:8704
    ds_read_b64 v[12:13], v102 offset:9216
    ds_read_b64 v[14:15], v102 offset:9728
    ds_read_b64 v[16:17], v102 offset:10240
    ds_read_b64 v[18:19], v102 offset:10752
    ds_read_b64 v[20:21], v102 offset:11264
    v_cvt_pk_bf16_f32 v150, 0, v150
    v_add_f32 v150, 0x3727c5ac, v150
    v_cvt_pk_bf16_f32 v150, 0, v150
    v_sqrt_f32 v150, v150
    v_cvt_pk_bf16_f32 v148, 0, v148
    v_cvt_pk_bf16_f32 v150, 0, v150
    v_rcp_f32 v150, v150
    s_nop 0
    v_mul_f32 v148, v148, v150
    v_fma_f32 v60, -v148, v44, v60
    v_fma_f32 v61, -v148, v45, v61
    s_waitcnt lgkmcnt(5)
    v_pk_add_f32 v[8:9], v[8:9], v[10:11]
    s_waitcnt lgkmcnt(3)
    v_pk_add_f32 v[12:13], v[12:13], v[14:15]
    v_pk_add_f32 v[8:9], v[8:9], v[12:13]
    s_waitcnt lgkmcnt(1)
    v_pk_add_f32 v[16:17], v[16:17], v[18:19]
    v_pk_add_f32 v[8:9], v[8:9], v[16:17]
    s_waitcnt lgkmcnt(0)
    v_pk_add_f32 v[8:9], v[8:9], v[20:21]
    v_pk_fma_f32 v[8:9], v[8:9], v[150:151], v[60:61] op_sel:[0,0,0] op_sel_hi:[1,0,1]
    s_nop 1
    v_cndmask_b32_dpp v10, v9, v8, vcc row_ror:8 row_mask:0xf bank_mask:0xf
    v_mov_b32_dpp v9, v8 row_ror:8 row_mask:0xf bank_mask:0x3
    v_cvt_pk_bf16_f32 v10, 0, v10
    v_mul_f32 v12, 0xbfb8aa3b, v10
    v_exp_f32 v12, v12
    v_cvt_pk_bf16_f32 v11, 0, v9
    v_add_f32 v12, 1.0, v12
    v_rcp_f32 v12, v12
    s_nop 0
    v_mul_f32 v10, v10, v12
    v_cvt_pk_bf16_f32 v10, 0, v10
    v_mul_f32 v10, v10, v11
    v_cvt_pk_bf16_f32 v10, 0, v10
    ds_write2_b32 v104, v10, v10 offset0:0 offset1:9
    s_waitcnt lgkmcnt(0)
    s_barrier
    ds_read_b32 v40, v106 offset:11904
    ds_read_b32 v42, v106 offset:13696
    s_waitcnt lgkmcnt(0)
    s_barrier
    s_mov_b32 s42, 0
poll_33:
    global_load_dwordx4 v[24:27], v108, s[30:31] sc1
    global_load_dwordx4 v[28:31], v108, s[30:31] offset:1024 sc1
    global_load_dwordx4 v[32:35], v108, s[30:31] offset:2048 sc1
    s_mov_b32 exec_hi, 0
    global_load_dwordx4 v[36:39], v108, s[30:31] offset:3072 sc1
    s_mov_b32 exec_hi, -1
    s_waitcnt vmcnt(0)
    v_bitop3_b32 v148, v26, v30, s32 bitop3:0x7e
    v_bitop3_b32 v149, v34, v38, s32 bitop3:0x7e
    v_or_b32 v148, v148, v149
    v_cmp_ne_u32 vcc, 0, v148
    s_cbranch_vccz pdone_34
    s_add_u32 s42, s42, 1
    s_cmp_lt_u32 s42, 200000
    s_cbranch_scc1 poll_33
pdone_34:
    v_pk_add_f32 v[24:25], v[24:25], v[28:29]
    v_pk_add_f32 v[32:33], v[32:33], v[36:37]
    v_pk_add_f32 v[24:25], v[24:25], v[32:33]
    s_nop 1
    v_permlane32_swap_b32 v24, v25
    v_add_f32 v24, v24, v25
    s_nop 1
    v_add_f32_dpp v24, v24, v24 row_ror:8 row_mask:0xf bank_mask:0xf
    v_mov_b32 v25, v24
    s_nop 1
    v_permlane16_swap_b32 v24, v25
    v_add_f32 v24, v24, v25
    v_cvt_pk_bf16_f32 v24, 0, v24
    v_mul_f32 v24, v24, v42
    v_cvt_pk_bf16_f32 v24, 0, v24
    v_add_f32 v24, v24, v40
    v_cvt_pk_bf16_f32 v24, 0, v24
    s_mov_b64 exec, s[56:57]
    global_store_short_d16_hi v107, v24, s[26:27]
    s_cmp_lg_u32 s45, 0
    s_cbranch_scc1 L_F_end
    s_mov_b64 exec, 1
    global_store_dword v110, v111, s[30:31]
L_F_end:
    s_endpgm
L_M:
    s_sub_u32 s44, s34, 4
    v_lshrrev_b32 v2, 3, v1
    v_and_b32 v3, 7, v1
    v_lshlrev_b32 v3, 4, v3
    s_mov_b32 s54, 0x00ff00ff
    s_mov_b32 s55, 0x00ff00ff
    v_lshrrev_b32 v149, 4, v1
    v_and_b32 v148, 7, v1
    v_lshl_add_u32 v148, v149, 3, v148
    s_lshl_b32 s36, s44, 11
    s_add_u32 s36, s36, 49920
    v_lshl_add_u32 v101, v148, 3, s36
    v_lshlrev_b32 v102, 3, v1
    s_min_u32 s38, s33, 6
    s_lshl_b32 s36, s38, 7
    v_lshl_add_u32 v148, v1, 1, s36
    s_mul_i32 s36, s38, 344064
    s_lshl_b32 s37, s44, 10
    s_add_u32 s36, s36, s37
    s_add_u32 s36, s36, 2176
    v_mul_u32_u24 v177, 43008, v2
    v_add3_u32 v177, v177, v3, s36
    v_add_u32 v178, 512, v177
    s_waitcnt lgkmcnt(0)
    s_load_dword s32, s[30:31], 0
    s_cmp_eq_u32 s33, 7
    s_cbranch_scc1 L_M7
    global_load_ushort v176, v148, s[22:23]
    global_load_dwordx4 v[8:11], v177, s[24:25] nt
    v_add_u32 v177, 5376, v177
    global_load_dwordx4 v[12:15], v177, s[24:25] nt
    v_add_u32 v177, 5376, v177
    global_load_dwordx4 v[16:19], v177, s[24:25] nt
    v_add_u32 v177, 5376, v177
    global_load_dwordx4 v[20:23], v177, s[24:25] nt
    v_add_u32 v177, 5376, v177
    global_load_dwordx4 v[24:27], v177, s[24:25] nt
    v_add_u32 v177, 5376, v177
    global_load_dwordx4 v[28:31], v177, s[24:25] nt
    v_add_u32 v177, 5376, v177
    global_load_dwordx4 v[32:35], v177, s[24:25] nt
    v_add_u32 v177, 5376, v177
    global_load_dwordx4 v[36:39], v177, s[24:25] nt
    s_lshl_b32 s47, s33, 10
    v_bfe_u32 v4, v1, 1, 1
    v_and_b32 v148, 1, v1
    v_lshl_or_b32 v4, v148, 1, v4
    v_mul_u32_u24 v4, 0x5555, v4
    v_mov_b32 v140, 0
    v_mov_b32 v141, 0
    v_mov_b32 v142, 0
    v_mov_b32 v143, 0
    v_mov_b32 v144, 0
    v_mov_b32 v145, 0
    v_mov_b32 v146, 0
    v_mov_b32 v147, 0
    v_lshl_add_u32 v148, v1, 4, s47
    ds_write_b128 v148, v[140:143]
    v_lshrrev_b32 v164, 4, v1
    v_lshl_add_u32 v164, v164, 6, s47
    v_bfe_u32 v148, v1, 2, 1
    v_lshl_add_u32 v164, v148, 5, v164
    v_bfe_u32 v148, v1, 3, 1
    v_lshl_add_u32 v164, v148, 4, v164
    v_and_b32 v182, 7, v1
    v_lshl_add_u32 v182, v182, 7, s47
    v_bfe_u32 v148, v1, 5, 1
    v_lshl_add_u32 v182, v148, 6, v182
    v_bfe_u32 v148, v1, 3, 1
    v_lshl_add_u32 v182, v148, 4, v182
    v_bfe_u32 v148, v1, 4, 1
    v_lshl_add_u32 v182, v148, 3, v182
    s_lshl_b32 s36, s33, 9
    v_lshl_add_u32 v165, v1, 3, s36
    s_waitcnt vmcnt(8)
    v_lshlrev_b32 v176, 16, v176
    v_mul_f32 v148, 0xbfb8aa3b, v176
    v_exp_f32 v148, v148
    s_nop 0
    v_add_f32 v148, 1.0, v148
    v_rcp_f32 v149, v148
    s_nop 0
    v_mul_f32 v150, v176, v149
    v_fma_f32 v148, -v150, v148, v176
    v_fma_f32 v148, v148, v149, v150
    v_cmp_o_f32 vcc, v148, v148
    s_nop 1
    v_cndmask_b32 v148, v150, v148, vcc
    v_cvt_pk_bf16_f32 v176, v148, 0
    ds_write2_b32 v182, v176, v176 offset0:0 offset1:9
    ds_read_b128 v[124:127], v164 offset:0
    ds_read_b128 v[128:131], v164 offset:256
    ds_read_b128 v[132:135], v164 offset:512
    ds_read_b128 v[136:139], v164 offset:768
    s_cmp_eq_u32 s44, 3
    s_cbranch_scc1 L_M_one
    global_load_dwordx4 v[40:43], v178, s[24:25] nt
    v_add_u32 v178, 5376, v178
    global_load_dwordx4 v[44:47], v178, s[24:25] nt
    v_add_u32 v178, 5376, v178
    global_load_dwordx4 v[48:51], v178, s[24:25] nt
    v_add_u32 v178, 5376, v178
    global_load_dwordx4 v[52:55], v178, s[24:25] nt
    v_add_u32 v178, 5376, v178
    global_load_dwordx4 v[56:59], v178, s[24:25] nt
    v_add_u32 v178, 5376, v178
    global_load_dwordx4 v[60:63], v178, s[24:25] nt
    v_add_u32 v178, 5376, v178
    global_load_dwordx4 v[64:67], v178, s[24:25] nt
    v_add_u32 v178, 5376, v178
    global_load_dwordx4 v[68:71], v178, s[24:25] nt
    s_waitcnt vmcnt(0) lgkmcnt(0)
    v_smfmac_f32_16x16x64_bf16 v[144:147], v[124:127], v[40:47], v4
    v_smfmac_f32_16x16x64_bf16 v[144:147], v[128:131], v[48:55], v4
    v_smfmac_f32_16x16x64_bf16 v[144:147], v[132:135], v[56:63], v4
    v_smfmac_f32_16x16x64_bf16 v[144:147], v[136:139], v[64:71], v4
    s_nop 7
    v_permlane32_swap_b32 v144, v145
    v_permlane32_swap_b32 v146, v147
    s_nop 0
    v_add_f32_dpp v144, v145, v144 row_ror:8 row_mask:0xf bank_mask:0xf
    v_add_f32_dpp v145, v147, v146 row_ror:8 row_mask:0xf bank_mask:0xf
    ds_write_b64 v165, v[144:145] offset:12288
L_M_one:
    s_waitcnt vmcnt(0) lgkmcnt(0)
    v_smfmac_f32_16x16x64_bf16 v[140:143], v[124:127], v[8:15], v4
    v_smfmac_f32_16x16x64_bf16 v[140:143], v[128:131], v[16:23], v4
    v_smfmac_f32_16x16x64_bf16 v[140:143], v[132:135], v[24:31], v4
    v_smfmac_f32_16x16x64_bf16 v[140:143], v[136:139], v[32:39], v4
    s_nop 7
    v_permlane32_swap_b32 v140, v141
    v_permlane32_swap_b32 v142, v143
    s_nop 0
    v_add_f32_dpp v140, v141, v140 row_ror:8 row_mask:0xf bank_mask:0xf
    v_add_f32_dpp v141, v143, v142 row_ror:8 row_mask:0xf bank_mask:0xf
    ds_write_b64 v165, v[140:141] offset:8192
    s_waitcnt lgkmcnt(0)
    s_barrier
    s_branch L_M_end
L_M7:
    s_waitcnt lgkmcnt(0)
    s_add_u32 s32, s32, 0x9e3779b9
    s_add_u32 s14, s30, 1048576
    s_addc_u32 s15, s31, 0
    s_barrier
    ds_read_b64 v[8:9], v102 offset:8192
    ds_read_b64 v[10:11], v102 offset:8704
    ds_read_b64 v[12:13], v102 offset:9216
    ds_read_b64 v[14:15], v102 offset:9728
    ds_read_b64 v[16:17], v102 offset:10240
    ds_read_b64 v[18:19], v102 offset:10752
    ds_read_b64 v[20:21], v102 offset:11264
    s_waitcnt lgkmcnt(5)
    v_pk_add_f32 v[8:9], v[8:9], v[10:11]
    s_waitcnt lgkmcnt(3)
    v_pk_add_f32 v[12:13], v[12:13], v[14:15]
    v_pk_add_f32 v[8:9], v[8:9], v[12:13]
    s_waitcnt lgkmcnt(1)
    v_pk_add_f32 v[16:17], v[16:17], v[18:19]
    v_pk_add_f32 v[8:9], v[8:9], v[16:17]
    s_waitcnt lgkmcnt(0)
    v_pk_add_f32 v[8:9], v[8:9], v[20:21]
    v_cvt_pk_bf16_f32 v8, v8, v9
    v_mov_b32 v9, s32
    s_mov_b64 exec, s[54:55]
    global_store_dwordx2 v101, v[8:9], s[30:31] sc1
    s_mov_b64 exec, -1
    s_cmp_eq_u32 s44, 3
    s_cbranch_scc1 L_M_end
    v_add_u32 v102, 4096, v102
    ds_read_b64 v[24:25], v102 offset:8192
    ds_read_b64 v[26:27], v102 offset:8704
    ds_read_b64 v[28:29], v102 offset:9216
    ds_read_b64 v[30:31], v102 offset:9728
    ds_read_b64 v[32:33], v102 offset:10240
    ds_read_b64 v[34:35], v102 offset:10752
    ds_read_b64 v[36:37], v102 offset:11264
    s_waitcnt lgkmcnt(5)
    v_pk_add_f32 v[24:25], v[24:25], v[26:27]
    s_waitcnt lgkmcnt(3)
    v_pk_add_f32 v[28:29], v[28:29], v[30:31]
    v_pk_add_f32 v[24:25], v[24:25], v[28:29]
    s_waitcnt lgkmcnt(1)
    v_pk_add_f32 v[32:33], v[32:33], v[34:35]
    v_pk_add_f32 v[24:25], v[24:25], v[32:33]
    s_waitcnt lgkmcnt(0)
    v_pk_add_f32 v[24:25], v[24:25], v[36:37]
    v_cvt_pk_bf16_f32 v24, v24, v25
    v_mov_b32 v25, s32
    s_mov_b64 exec, s[54:55]
    global_store_dwordx2 v101, v[24:25], s[30:31] offset:1024 sc1
L_M_end:
    s_endpgm
L_exit:
    s_endpgm

.section .rodata,"a"
.p2align 6
.amdhsa_kernel adaLN_cond__sliding_block_cached__swiglu_ffn__decode_kernel
  .amdhsa_next_free_vgpr 256
  .amdhsa_next_free_sgpr 102
  .amdhsa_accum_offset 256
  .amdhsa_group_segment_fixed_size 0
  .amdhsa_kernarg_size 112
  .amdhsa_user_sgpr_count 2
  .amdhsa_user_sgpr_kernarg_segment_ptr 1
  .amdhsa_system_sgpr_workgroup_id_x 1
  .amdhsa_float_denorm_mode_32 3
.end_amdhsa_kernel
```
